```python
import torch

def _softmax(x, axis=-1):
    return torch.softmax(x, dim=axis)
def _gelu(x):
    return torch.nn.functional.gelu(x, approximate="tanh")
def _silu(x):
    return torch.nn.functional.silu(x)
def _sigmoid(x):
    return torch.sigmoid(x)
def _layernorm(x, axis=-1, eps=1e-5):
    m = x.mean(dim=axis, keepdim=True)
    v = x.var(dim=axis, keepdim=True, unbiased=False)
    return (x - m) / torch.sqrt(v + eps)
def _scatter_add(tgt, idx, src, axis=0):
    return tgt.clone().index_add_(axis, idx, src)
def _segment_sum(src, seg, n):
    out = torch.zeros((n,) + src.shape[1:], dtype=src.dtype)
    return out.index_add_(0, seg, src)
def _pad(x, pw):
    flat = tuple(v for pair in reversed(pw) for v in pair)
    return torch.nn.functional.pad(x, flat)

kernel_name = 'recurrent_scan__gqa_block_cached__geglu_ffn__decode'

def setup_inputs():

    _w = (lambda a: (lambda t: t.to(torch.bfloat16) if t.is_floating_point() else t)(torch.as_tensor(a)))
    def _A_setup():
        B, Sq, D = 1, 1, 640
        Hq, Hkv, Sk, Dh = 32, 32, 32768, 128
        assert Hq % Hkv == 0, (Hq, Hkv)
        return {
            "x": _w((lambda *s: torch.randn(*s, dtype=torch.bfloat16) * 0.05)(B, Sq, D)),
            "k_cache": _w((lambda *s: torch.randn(*s, dtype=torch.bfloat16) * 3.2)(B, Hkv, Sk, Dh)),
            "v_cache": _w((lambda *s: torch.randn(*s, dtype=torch.bfloat16) * 0.8)(B, Hkv, Sk, Dh)),
            "wq": _w((lambda *s: torch.randn(*s, dtype=torch.bfloat16) * 3.2)(D, Hq * Dh) * (D ** -0.5)),
            "wo": _w((lambda *s: torch.randn(*s, dtype=torch.bfloat16) * 0.8)(Hq * Dh, D) * ((Hq * Dh) ** -0.5)),
        }
    _A_in = _A_setup()

    def _B_setup():
        B, S, D, F = 1, 1, 640, 1728
        return {
            "x": _w((lambda *s: torch.randn(*s, dtype=torch.bfloat16) * 0.05)(B, S, D)),
            "w_gate": _w((lambda *s: torch.randn(*s, dtype=torch.bfloat16) * 0.4)(D, F)),
            "w_up": _w((lambda *s: torch.randn(*s, dtype=torch.bfloat16) * 0.4)(D, F)),
            "w_down": _w((lambda *s: torch.randn(*s, dtype=torch.bfloat16) * 0.4)(F, D)),
        }
    _B_in = _B_setup()

    return {
        "A_x": _A_in["x"],
        "A_k_cache": _A_in["k_cache"],
        "A_v_cache": _A_in["v_cache"],
        "A_wq": _A_in["wq"],
        "A_wo": _A_in["wo"],
        "B_x": _B_in["x"],
        "B_w_gate": _B_in["w_gate"],
        "B_w_up": _B_in["w_up"],
        "B_w_down": _B_in["w_down"],
    }

def reference(A_x, A_k_cache, A_v_cache, A_wq, A_wo, B_x, B_w_gate, B_w_up, B_w_down):
    def _A_ref(x, k_cache, v_cache, wq, wo):
        B, Sq, D = x.shape
        Hq, Dh = 32, 128
        Hkv = k_cache.shape[1]
        rep = Hq // Hkv
        q = (lambda x, *d: x.permute(*d))((x @ wq).reshape(B, Sq, Hq, Dh), 0, 2, 1, 3)
        k = (lambda x, n, axis: torch.repeat_interleave(x, n, dim=axis))(k_cache, rep, axis=1)
        v = (lambda x, n, axis: torch.repeat_interleave(x, n, dim=axis))(v_cache, rep, axis=1)
        scores = torch.einsum("bhqd,bhkd->bhqk", q, k) * (Dh ** -0.5)
        p = _softmax(scores, axis=-1)
        o = torch.einsum("bhqk,bhkd->bhqd", p, v)
        return (lambda x, *d: x.permute(*d))(o, 0, 2, 1, 3).reshape(B, Sq, Hq * Dh) @ wo

    def _B_ref(x, w_gate, w_up, w_down):
        return (_gelu(x @ w_gate) * (x @ w_up)) @ w_down

    x = A_x
    xn = _layernorm(x, axis=-1)
    s = _A_ref(xn, A_k_cache, A_v_cache, A_wq, A_wo)
    g = _silu(_B_ref(xn, B_w_gate, B_w_up, B_w_down))
    return x + s * g
```

```asm
; @launch grid=(256,1,1) block=(320,1,1) lds=54544
.amdgcn_target "amdgcn-amd-amdhsa--gfx950"
.text
.globl recurrent_scan__gqa_block_cached__geglu_ffn__decode_kernel
.p2align 8
.type recurrent_scan__gqa_block_cached__geglu_ffn__decode_kernel,@function
recurrent_scan__gqa_block_cached__geglu_ffn__decode_kernel:
    s_load_dwordx16 s[4:19], s[0:1], 0
    s_load_dwordx8 s[20:27], s[0:1], 64
    v_readfirstlane_b32 s3, v0
    s_cmpk_ge_u32 s2, 256
    s_cbranch_scc1 L_end
    v_mov_b32 v29, 0
    v_and_b32 v1, 63, v0
    ds_write_b32 v29, v29 offset:2368
    v_lshlrev_b32 v2, 4, v1
    v_and_b32 v3, 0xf0, v2
    s_lshr_b32 s52, s2, 3
    s_lshl_b32 s32, s52, 23
    v_bfe_i32 v4, v0, 4, 1
    v_and_b32 v4, 256, v4
    v_xor_b32 v3, v3, v4
    v_bfe_i32 v4, v0, 5, 1
    v_and_b32 v4, 2048, v4
    v_xor_b32 v3, v3, v4
    s_bitcmp1_b32 s3, 6
    s_cselect_b32 s35, 659456, 0
    s_xor_b32 s32, s32, s35
    s_bitcmp1_b32 s3, 7
    s_cselect_b32 s35, 8704, 0
    s_xor_b32 s32, s32, s35
    s_bitcmp1_b32 s2, 0
    s_cselect_b32 s35, 2097152, 0
    s_xor_b32 s32, s32, s35
    s_bitcmp1_b32 s2, 1
    s_cselect_b32 s35, 1573376, 0
    s_xor_b32 s32, s32, s35
    s_bitcmp1_b32 s2, 2
    s_cselect_b32 s35, 6291456, 0
    s_xor_b32 s32, s32, s35
    s_bitcmp1_b32 s2, 3
    s_cselect_b32 s35, 1048576, 0
    s_xor_b32 s32, s32, s35
    s_bitcmp1_b32 s2, 4
    s_cselect_b32 s35, 2490368, 0
    s_xor_b32 s32, s32, s35
    s_bitcmp1_b32 s2, 5
    s_cselect_b32 s35, 4718592, 0
    s_xor_b32 s32, s32, s35
    s_bitcmp1_b32 s2, 6
    s_cselect_b32 s35, 4096, 0
    s_xor_b32 s32, s32, s35
    s_mov_b32 s33, 1
    v_xor_b32 v206, s32, v3
    s_brev_b32 s30, 8
    s_lshl_b32 s31, 1, 17
    s_cmpk_ge_u32 s3, 256
    s_waitcnt lgkmcnt(0)
    s_barrier
    s_cbranch_scc1 L_helper
    s_mov_b64 s[28:29], s[6:7]
    buffer_load_dwordx4 v[32:35], v206, s[28:31], 0 offen nt
    v_xor_b32 v207, 73728, v206
    buffer_load_dwordx4 v[36:39], v207, s[28:31], 0 offen nt
    v_xor_b32 v207, 4194816, v206
    buffer_load_dwordx4 v[40:43], v207, s[28:31], 0 offen nt
    v_xor_b32 v207, 4268544, v206
    buffer_load_dwordx4 v[44:47], v207, s[28:31], 0 offen nt
    v_xor_b32 v207, 147456, v206
    buffer_load_dwordx4 v[48:51], v207, s[28:31], 0 offen nt
    s_lshr_b32 s3, s3, 6
    s_lshr_b32 s52, s2, 3
    s_add_u32 s69, s2, s52
    s_and_b32 s69, s69, 7
    s_load_dword s55, s[26:27], 4
    v_lshrrev_b32 v6, 4, v1
    v_and_b32 v7, 15, v1
    s_mov_b32 s57, 4000000
    s_mov_b32 s62, 0x3fb8aa3b
    s_mov_b32 s44, s26
    s_mov_b32 s45, s27
    s_mov_b32 s46, 1703936
    s_mov_b32 s47, 0x20000
    s_mov_b32 s58, 0xcccccccc
    s_mov_b32 s59, 0xcccccccc
    s_mov_b32 s60, 0xaaaaaaaa
    s_mov_b32 s61, 0xaaaaaaaa
    s_mov_b32 s63, 0x3db504f3
    v_xor_b32 v207, 221184, v206
    s_waitcnt vmcnt(4)
    buffer_load_dwordx4 v[52:55], v207, s[28:31], 0 offen nt
    v_lshlrev_b32 v166, 5, v7
    v_lshl_add_u32 v166, v6, 3, v166
    s_lshl_b32 s64, s3, 9
    v_add_u32 v166, s64, v166
    v_xor_b32 v207, 4342272, v206
    s_waitcnt vmcnt(4)
    buffer_load_dwordx4 v[56:59], v207, s[28:31], 0 offen nt
    s_mul_i32 s64, s3, 8768
    v_mul_u32_u24 v160, 272, v6
    v_lshl_add_u32 v160, v7, 4, v160
    v_add_u32 v160, s64, v160
    v_xor_b32 v207, 4416000, v206
    s_waitcnt vmcnt(4)
    buffer_load_dwordx4 v[60:63], v207, s[28:31], 0 offen nt
    v_mul_u32_u24 v200, 2560, v6
    v_lshl_add_u32 v200, v7, 4, v200
    v_lshrrev_b32 v201, 2, v7
    v_mul_u32_u24 v201, 8768, v201
    v_xor_b32 v207, 180224, v206
    s_waitcnt vmcnt(4)
    buffer_load_dwordx4 v[64:67], v207, s[28:31], 0 offen nt
    v_mul_u32_u24 v202, 2176, v6
    v_add_u32 v201, v201, v202
    v_and_b32 v202, 3, v7
    v_mul_u32_u24 v202, 272, v202
    v_xor_b32 v207, 253952, v206
    s_waitcnt vmcnt(4)
    buffer_load_dwordx4 v[68:71], v207, s[28:31], 0 offen nt
    v_add_u32 v201, v201, v202
    s_lshl_b32 s64, s3, 6
    v_add_u32 v201, s64, v201
    s_mul_i32 s39, s52, 163840
    v_xor_b32 v207, 4375040, v206
    s_waitcnt vmcnt(4)
    buffer_load_dwordx4 v[72:75], v207, s[28:31], 0 offen nt
    s_lshl_b32 s64, s69, 8
    s_add_u32 s39, s39, s64
    s_mul_i32 s64, s3, 40960
    s_add_u32 s39, s39, s64
    v_xor_b32 v207, 4448768, v206
    s_waitcnt vmcnt(4)
    buffer_load_dwordx4 v[76:79], v207, s[28:31], 0 offen nt
    s_sub_u32 s38, s69, 5
    s_lshl_b32 s38, s38, 1
    s_lshr_b32 s64, s3, 1
    s_add_u32 s38, s38, s64
    v_xor_b32 v207, 32768, v206
    s_waitcnt vmcnt(4)
    buffer_load_dwordx4 v[80:83], v207, s[28:31], 0 offen nt
    s_mul_i32 s37, s52, 81920
    s_lshl_b32 s64, s38, 8
    s_add_u32 s37, s37, s64
    s_and_b32 s36, s3, 1
    v_xor_b32 v207, 106496, v206
    s_waitcnt vmcnt(4)
    buffer_load_dwordx4 v[84:87], v207, s[28:31], 0 offen nt
    s_mul_i32 s64, s36, 40960
    s_add_u32 s37, s37, s64
    s_mov_b32 s42, 2211840
    s_cmp_ge_u32 s38, 5
    v_xor_b32 v207, 4227584, v206
    s_waitcnt vmcnt(4)
    buffer_load_dwordx4 v[88:91], v207, s[28:31], 0 offen nt
    s_cselect_b32 s42, 0, s42
    s_cmp_ge_u32 s52, 27
    s_cselect_b32 s42, 0, s42
    s_cmp_lt_u32 s69, 5
    v_xor_b32 v207, 4301312, v206
    s_waitcnt vmcnt(4)
    buffer_load_dwordx4 v[92:95], v207, s[28:31], 0 offen nt
    s_cselect_b32 s40, s12, s20
    s_cselect_b32 s41, s13, s21
    s_cselect_b32 s42, 5242880, s42
    s_cselect_b32 s39, s39, s37
    v_xor_b32 v207, 6947840, v206
    s_waitcnt vmcnt(4)
    buffer_load_dwordx4 v[96:99], v207, s[28:31], 0 offen nt
    s_mov_b32 s43, 0x20000
    s_mul_i32 s37, s52, 10240
    s_mul_i32 s64, s36, 5120
    s_add_u32 s37, s37, s64
    v_xor_b32 v207, 7021568, v206
    s_waitcnt vmcnt(4)
    buffer_load_dwordx4 v[100:103], v207, s[28:31], 0 offen nt
    s_lshl_b32 s64, s38, 10
    s_add_u32 s37, s37, s64
    s_add_u32 s37, s37, 1310720
    v_bfe_u32 v202, v1, 1, 2
    v_xor_b32 v207, 2754048, v206
    s_waitcnt vmcnt(4)
    buffer_load_dwordx4 v[104:107], v207, s[28:31], 0 offen nt
    v_lshlrev_b32 v202, 6, v202
    v_lshl_add_u32 v202, v6, 4, v202
    v_and_b32 v203, 1, v1
    v_lshl_add_u32 v202, v203, 3, v202
    v_xor_b32 v207, 2827776, v206
    s_waitcnt vmcnt(4)
    buffer_load_dwordx4 v[108:111], v207, s[28:31], 0 offen nt
    s_lshl_b32 s64, s36, 8
    v_add_u32 v202, s64, v202
    v_lshlrev_b32 v203, 6, v7
    v_lshl_add_u32 v203, v6, 4, v203
    v_xor_b32 v207, 6833152, v206
    s_waitcnt vmcnt(4)
    buffer_load_dwordx4 v[112:115], v207, s[28:31], 0 offen nt
    v_lshlrev_b32 v162, 11, v6
    v_lshl_add_u32 v161, v7, 4, v162
    v_bfe_u32 v163, v1, 1, 4
    v_lshlrev_b32 v163, 5, v163
    v_xor_b32 v207, 6906880, v206
    s_waitcnt vmcnt(4)
    buffer_load_dwordx4 v[116:119], v207, s[28:31], 0 offen nt
    v_lshrrev_b32 v164, 5, v1
    v_lshl_add_u32 v163, v164, 4, v163
    v_and_b32 v164, 1, v1
    v_lshl_add_u32 v163, v164, 3, v163
    v_xor_b32 v207, 2639360, v206
    s_waitcnt vmcnt(4)
    buffer_load_dwordx4 v[120:123], v207, s[28:31], 0 offen nt
    v_lshlrev_b32 v164, 3, v1
    v_lshrrev_b32 v165, 2, v1
    v_lshlrev_b32 v165, 4, v165
    s_lshl_b32 s64, s2, 10
    v_xor_b32 v207, 2713088, v206
    s_waitcnt vmcnt(4)
    buffer_load_dwordx4 v[124:127], v207, s[28:31], 0 offen nt
    s_add_u32 s64, s64, 524288
    s_cmp_eq_u32 s3, 0
    s_cselect_b32 s65, s64, 0x7f000000
    s_lshl_b32 s66, s52, 13
    v_xor_b32 v207, 6865920, v206
    s_waitcnt vmcnt(4)
    buffer_load_dwordx4 v[128:131], v207, s[28:31], 0 offen nt
    s_add_u32 s66, s66, 524288
    s_lshl_b32 s67, s69, 2
    s_add_u32 s67, s67, s3
    s_lshl_b32 s67, s67, 8
    v_xor_b32 v207, 6939648, v206
    s_waitcnt vmcnt(4)
    buffer_load_dwordx4 v[132:135], v207, s[28:31], 0 offen nt
    s_mul_i32 s68, s52, 5120
    s_add_u32 s67, s67, s68
    s_add_u32 s67, s67, 1048576
    v_lshlrev_b32 v167, 4, v7
    v_xor_b32 v207, 2672128, v206
    s_waitcnt vmcnt(4)
    buffer_load_dwordx4 v[136:139], v207, s[28:31], 0 offen nt
    s_lshl_b32 s68, s3, 12
    v_add_u32 v20, s68, v164
    v_mov_b32 v10, 0
    v_mov_b32 v11, 0
    v_xor_b32 v207, 2745856, v206
    s_waitcnt vmcnt(4)
    buffer_load_dwordx4 v[140:143], v207, s[28:31], 0 offen nt
    v_mov_b32 v12, 0
    v_mov_b32 v13, 0
    v_mov_b32 v14, 0
    v_mov_b32 v15, 0
    v_xor_b32 v207, 6980608, v206
    s_waitcnt vmcnt(4)
    buffer_load_dwordx4 v[144:147], v207, s[28:31], 0 offen nt
    v_mov_b32 v16, 0
    v_mov_b32 v17, 0
    v_mov_b32 v18, 0xff61b1e6
    v_mov_b32 v19, 0
    v_xor_b32 v207, 7054336, v206
    s_waitcnt vmcnt(4)
    buffer_load_dwordx4 v[148:151], v207, s[28:31], 0 offen nt
    s_mov_b32 s56, 0
    v_mov_b32 v22, 0
    v_xor_b32 v207, 2786816, v206
    s_waitcnt vmcnt(4)
    buffer_load_dwordx4 v[152:155], v207, s[28:31], 0 offen nt
    v_xor_b32 v207, 2860544, v206
    s_waitcnt vmcnt(4)
    buffer_load_dwordx4 v[156:159], v207, s[28:31], 0 offen nt
L_qwait:
    ds_read_b32 v23, v22 offset:2368
    ds_read_b128 v[6:9], v167 offset:2048
    s_sub_u32 s57, s57, 1
    s_waitcnt lgkmcnt(0)
    v_cmp_eq_u32 vcc, 0, v23
    s_cmp_lt_i32 s57, 0
    s_cbranch_scc1 L_qgo
    s_cbranch_vccnz L_qwait
L_qgo:
    s_add_u32 s55, s55, 1
L_kloop:
    s_mov_b32 s54, s32
    s_bitcmp1_b32 s33, 0
    s_cselect_b32 s35, 7079936, 0
    s_xor_b32 s54, s54, s35
    s_bitcmp1_b32 s33, 1
    s_cselect_b32 s35, 4718592, 0
    s_xor_b32 s54, s54, s35
    s_bitcmp1_b32 s33, 2
    s_cselect_b32 s35, 5374464, 0
    s_xor_b32 s54, s54, s35
    s_add_u32 s33, s33, 1
    v_xor_b32 v206, s54, v3
    s_cmp_eq_u32 s56, 7
    s_cselect_b32 s28, s8, s28
    s_cselect_b32 s29, s9, s29
    v_dot2_f32_bf16 v22, v32, v6, 0
    v_dot2_f32_bf16 v22, v33, v7, v22
    v_dot2_f32_bf16 v22, v34, v8, v22
    v_dot2_f32_bf16 v22, v35, v9, v22
    s_waitcnt vmcnt(4)
    buffer_load_dwordx4 v[32:35], v206, s[28:31], 0 offen nt
    v_dot2_f32_bf16 v23, v36, v6, 0
    v_dot2_f32_bf16 v23, v37, v7, v23
    v_dot2_f32_bf16 v23, v38, v8, v23
    v_dot2_f32_bf16 v23, v39, v9, v23
    v_xor_b32 v207, 73728, v206
    s_waitcnt vmcnt(4)
    buffer_load_dwordx4 v[36:39], v207, s[28:31], 0 offen nt
    v_add_f32_dpp v24, v22, v22 row_ror:8 row_mask:0xf bank_mask:0x3
    s_nop 1
    v_add_f32_dpp v24, v23, v23 row_ror:8 row_mask:0xf bank_mask:0xc
    v_dot2_f32_bf16 v22, v40, v6, 0
    v_dot2_f32_bf16 v22, v41, v7, v22
    v_dot2_f32_bf16 v22, v42, v8, v22
    v_dot2_f32_bf16 v22, v43, v9, v22
    v_xor_b32 v207, 4194816, v206
    s_waitcnt vmcnt(4)
    buffer_load_dwordx4 v[40:43], v207, s[28:31], 0 offen nt
    v_dot2_f32_bf16 v23, v44, v6, 0
    v_dot2_f32_bf16 v23, v45, v7, v23
    v_dot2_f32_bf16 v23, v46, v8, v23
    v_dot2_f32_bf16 v23, v47, v9, v23
    v_xor_b32 v207, 4268544, v206
    s_waitcnt vmcnt(4)
    buffer_load_dwordx4 v[44:47], v207, s[28:31], 0 offen nt
    v_add_f32_dpp v25, v22, v22 row_ror:8 row_mask:0xf bank_mask:0x3
    s_nop 1
    v_add_f32_dpp v25, v23, v23 row_ror:8 row_mask:0xf bank_mask:0xc
    v_add_f32_dpp v26, v24, v24 row_half_mirror row_mask:0xf bank_mask:0x5
    s_nop 1
    v_add_f32_dpp v26, v25, v25 row_half_mirror row_mask:0xf bank_mask:0xa
    v_dot2_f32_bf16 v22, v48, v6, 0
    v_dot2_f32_bf16 v22, v49, v7, v22
    v_dot2_f32_bf16 v22, v50, v8, v22
    v_dot2_f32_bf16 v22, v51, v9, v22
    v_xor_b32 v207, 147456, v206
    s_waitcnt vmcnt(4)
    buffer_load_dwordx4 v[48:51], v207, s[28:31], 0 offen nt
    v_dot2_f32_bf16 v23, v52, v6, 0
    v_dot2_f32_bf16 v23, v53, v7, v23
    v_dot2_f32_bf16 v23, v54, v8, v23
    v_dot2_f32_bf16 v23, v55, v9, v23
    v_xor_b32 v207, 221184, v206
    s_waitcnt vmcnt(4)
    buffer_load_dwordx4 v[52:55], v207, s[28:31], 0 offen nt
    v_add_f32_dpp v24, v22, v22 row_ror:8 row_mask:0xf bank_mask:0x3
    s_nop 1
    v_add_f32_dpp v24, v23, v23 row_ror:8 row_mask:0xf bank_mask:0xc
    v_dot2_f32_bf16 v22, v56, v6, 0
    v_dot2_f32_bf16 v22, v57, v7, v22
    v_dot2_f32_bf16 v22, v58, v8, v22
    v_dot2_f32_bf16 v22, v59, v9, v22
    v_xor_b32 v207, 4342272, v206
    s_waitcnt vmcnt(4)
    buffer_load_dwordx4 v[56:59], v207, s[28:31], 0 offen nt
    v_dot2_f32_bf16 v23, v60, v6, 0
    v_dot2_f32_bf16 v23, v61, v7, v23
    v_dot2_f32_bf16 v23, v62, v8, v23
    v_dot2_f32_bf16 v23, v63, v9, v23
    v_xor_b32 v207, 4416000, v206
    s_waitcnt vmcnt(4)
    buffer_load_dwordx4 v[60:63], v207, s[28:31], 0 offen nt
    v_add_f32_dpp v25, v22, v22 row_ror:8 row_mask:0xf bank_mask:0x3
    s_nop 1
    v_add_f32_dpp v25, v23, v23 row_ror:8 row_mask:0xf bank_mask:0xc
    v_add_f32_dpp v27, v24, v24 row_half_mirror row_mask:0xf bank_mask:0x5
    s_nop 1
    v_add_f32_dpp v27, v25, v25 row_half_mirror row_mask:0xf bank_mask:0xa
    v_add_f32_dpp v30, v26, v26 quad_perm:[2,3,0,1] row_mask:0xf bank_mask:0xf
    s_nop 0
    v_add_f32_dpp v31, v27, v27 quad_perm:[2,3,0,1] row_mask:0xf bank_mask:0xf
    v_cndmask_b32 v28, v30, v31, s[58:59]
    v_dot2_f32_bf16 v22, v64, v6, 0
    v_dot2_f32_bf16 v22, v65, v7, v22
    v_dot2_f32_bf16 v22, v66, v8, v22
    v_dot2_f32_bf16 v22, v67, v9, v22
    v_xor_b32 v207, 180224, v206
    s_waitcnt vmcnt(4)
    buffer_load_dwordx4 v[64:67], v207, s[28:31], 0 offen nt
    v_dot2_f32_bf16 v23, v68, v6, 0
    v_dot2_f32_bf16 v23, v69, v7, v23
    v_dot2_f32_bf16 v23, v70, v8, v23
    v_dot2_f32_bf16 v23, v71, v9, v23
    v_xor_b32 v207, 253952, v206
    s_waitcnt vmcnt(4)
    buffer_load_dwordx4 v[68:71], v207, s[28:31], 0 offen nt
    v_add_f32_dpp v24, v22, v22 row_ror:8 row_mask:0xf bank_mask:0x3
    s_nop 1
    v_add_f32_dpp v24, v23, v23 row_ror:8 row_mask:0xf bank_mask:0xc
    v_dot2_f32_bf16 v22, v72, v6, 0
    v_dot2_f32_bf16 v22, v73, v7, v22
    v_dot2_f32_bf16 v22, v74, v8, v22
    v_dot2_f32_bf16 v22, v75, v9, v22
    v_xor_b32 v207, 4375040, v206
    s_waitcnt vmcnt(4)
    buffer_load_dwordx4 v[72:75], v207, s[28:31], 0 offen nt
    v_dot2_f32_bf16 v23, v76, v6, 0
    v_dot2_f32_bf16 v23, v77, v7, v23
    v_dot2_f32_bf16 v23, v78, v8, v23
    v_dot2_f32_bf16 v23, v79, v9, v23
    v_xor_b32 v207, 4448768, v206
    s_waitcnt vmcnt(4)
    buffer_load_dwordx4 v[76:79], v207, s[28:31], 0 offen nt
    v_add_f32_dpp v25, v22, v22 row_ror:8 row_mask:0xf bank_mask:0x3
    s_nop 1
    v_add_f32_dpp v25, v23, v23 row_ror:8 row_mask:0xf bank_mask:0xc
    v_add_f32_dpp v26, v24, v24 row_half_mirror row_mask:0xf bank_mask:0x5
    s_nop 1
    v_add_f32_dpp v26, v25, v25 row_half_mirror row_mask:0xf bank_mask:0xa
    v_dot2_f32_bf16 v22, v80, v6, 0
    v_dot2_f32_bf16 v22, v81, v7, v22
    v_dot2_f32_bf16 v22, v82, v8, v22
    v_dot2_f32_bf16 v22, v83, v9, v22
    v_xor_b32 v207, 32768, v206
    s_waitcnt vmcnt(4)
    buffer_load_dwordx4 v[80:83], v207, s[28:31], 0 offen nt
    v_dot2_f32_bf16 v23, v84, v6, 0
    v_dot2_f32_bf16 v23, v85, v7, v23
    v_dot2_f32_bf16 v23, v86, v8, v23
    v_dot2_f32_bf16 v23, v87, v9, v23
    v_xor_b32 v207, 106496, v206
    s_waitcnt vmcnt(4)
    buffer_load_dwordx4 v[84:87], v207, s[28:31], 0 offen nt
    v_add_f32_dpp v24, v22, v22 row_ror:8 row_mask:0xf bank_mask:0x3
    s_nop 1
    v_add_f32_dpp v24, v23, v23 row_ror:8 row_mask:0xf bank_mask:0xc
    v_dot2_f32_bf16 v22, v88, v6, 0
    v_dot2_f32_bf16 v22, v89, v7, v22
    v_dot2_f32_bf16 v22, v90, v8, v22
    v_dot2_f32_bf16 v22, v91, v9, v22
    v_xor_b32 v207, 4227584, v206
    s_waitcnt vmcnt(4)
    buffer_load_dwordx4 v[88:91], v207, s[28:31], 0 offen nt
    v_dot2_f32_bf16 v23, v92, v6, 0
    v_dot2_f32_bf16 v23, v93, v7, v23
    v_dot2_f32_bf16 v23, v94, v8, v23
    v_dot2_f32_bf16 v23, v95, v9, v23
    v_xor_b32 v207, 4301312, v206
    s_waitcnt vmcnt(4)
    buffer_load_dwordx4 v[92:95], v207, s[28:31], 0 offen nt
    v_add_f32_dpp v25, v22, v22 row_ror:8 row_mask:0xf bank_mask:0x3
    s_nop 1
    v_add_f32_dpp v25, v23, v23 row_ror:8 row_mask:0xf bank_mask:0xc
    v_add_f32_dpp v27, v24, v24 row_half_mirror row_mask:0xf bank_mask:0x5
    s_nop 1
    v_add_f32_dpp v27, v25, v25 row_half_mirror row_mask:0xf bank_mask:0xa
    v_add_f32_dpp v30, v26, v26 quad_perm:[2,3,0,1] row_mask:0xf bank_mask:0xf
    s_nop 0
    v_add_f32_dpp v31, v27, v27 quad_perm:[2,3,0,1] row_mask:0xf bank_mask:0xf
    v_cndmask_b32 v29, v30, v31, s[58:59]
    v_add_f32_dpp v30, v28, v28 quad_perm:[1,0,3,2] row_mask:0xf bank_mask:0xf
    s_nop 0
    v_add_f32_dpp v31, v29, v29 quad_perm:[1,0,3,2] row_mask:0xf bank_mask:0xf
    v_cndmask_b32 v4, v30, v31, s[60:61]
    v_cvt_pk_bf16_f32 v4, 0, v4
    v_mul_f32 v4, s63, v4
    v_cvt_pk_bf16_f32 v4, 0, v4
    v_dot2_f32_bf16 v22, v96, v6, 0
    v_dot2_f32_bf16 v22, v97, v7, v22
    v_dot2_f32_bf16 v22, v98, v8, v22
    v_dot2_f32_bf16 v22, v99, v9, v22
    v_xor_b32 v207, 6947840, v206
    s_waitcnt vmcnt(4)
    buffer_load_dwordx4 v[96:99], v207, s[28:31], 0 offen nt
    v_dot2_f32_bf16 v23, v100, v6, 0
    v_dot2_f32_bf16 v23, v101, v7, v23
    v_dot2_f32_bf16 v23, v102, v8, v23
    v_dot2_f32_bf16 v23, v103, v9, v23
    v_xor_b32 v207, 7021568, v206
    s_waitcnt vmcnt(4)
    buffer_load_dwordx4 v[100:103], v207, s[28:31], 0 offen nt
    v_add_f32_dpp v24, v22, v22 row_ror:8 row_mask:0xf bank_mask:0x3
    s_nop 1
    v_add_f32_dpp v24, v23, v23 row_ror:8 row_mask:0xf bank_mask:0xc
    v_dot2_f32_bf16 v22, v104, v6, 0
    v_dot2_f32_bf16 v22, v105, v7, v22
    v_dot2_f32_bf16 v22, v106, v8, v22
    v_dot2_f32_bf16 v22, v107, v9, v22
    v_xor_b32 v207, 2754048, v206
    s_waitcnt vmcnt(4)
    buffer_load_dwordx4 v[104:107], v207, s[28:31], 0 offen nt
    v_dot2_f32_bf16 v23, v108, v6, 0
    v_dot2_f32_bf16 v23, v109, v7, v23
    v_dot2_f32_bf16 v23, v110, v8, v23
    v_dot2_f32_bf16 v23, v111, v9, v23
    v_xor_b32 v207, 2827776, v206
    s_waitcnt vmcnt(4)
    buffer_load_dwordx4 v[108:111], v207, s[28:31], 0 offen nt
    v_add_f32_dpp v25, v22, v22 row_ror:8 row_mask:0xf bank_mask:0x3
    s_nop 1
    v_add_f32_dpp v25, v23, v23 row_ror:8 row_mask:0xf bank_mask:0xc
    v_add_f32_dpp v26, v24, v24 row_half_mirror row_mask:0xf bank_mask:0x5
    s_nop 1
    v_add_f32_dpp v26, v25, v25 row_half_mirror row_mask:0xf bank_mask:0xa
    v_dot2_f32_bf16 v22, v112, v6, 0
    v_dot2_f32_bf16 v22, v113, v7, v22
    v_dot2_f32_bf16 v22, v114, v8, v22
    v_dot2_f32_bf16 v22, v115, v9, v22
    v_xor_b32 v207, 6833152, v206
    s_waitcnt vmcnt(4)
    buffer_load_dwordx4 v[112:115], v207, s[28:31], 0 offen nt
    v_dot2_f32_bf16 v23, v116, v6, 0
    v_dot2_f32_bf16 v23, v117, v7, v23
    v_dot2_f32_bf16 v23, v118, v8, v23
    v_dot2_f32_bf16 v23, v119, v9, v23
    v_xor_b32 v207, 6906880, v206
    s_waitcnt vmcnt(4)
    buffer_load_dwordx4 v[116:119], v207, s[28:31], 0 offen nt
    v_add_f32_dpp v24, v22, v22 row_ror:8 row_mask:0xf bank_mask:0x3
    s_nop 1
    v_add_f32_dpp v24, v23, v23 row_ror:8 row_mask:0xf bank_mask:0xc
    v_dot2_f32_bf16 v22, v120, v6, 0
    v_dot2_f32_bf16 v22, v121, v7, v22
    v_dot2_f32_bf16 v22, v122, v8, v22
    v_dot2_f32_bf16 v22, v123, v9, v22
    v_xor_b32 v207, 2639360, v206
    s_waitcnt vmcnt(4)
    buffer_load_dwordx4 v[120:123], v207, s[28:31], 0 offen nt
    v_dot2_f32_bf16 v23, v124, v6, 0
    v_dot2_f32_bf16 v23, v125, v7, v23
    v_dot2_f32_bf16 v23, v126, v8, v23
    v_dot2_f32_bf16 v23, v127, v9, v23
    v_xor_b32 v207, 2713088, v206
    s_waitcnt vmcnt(4)
    buffer_load_dwordx4 v[124:127], v207, s[28:31], 0 offen nt
    v_add_f32_dpp v25, v22, v22 row_ror:8 row_mask:0xf bank_mask:0x3
    s_nop 1
    v_add_f32_dpp v25, v23, v23 row_ror:8 row_mask:0xf bank_mask:0xc
    v_add_f32_dpp v27, v24, v24 row_half_mirror row_mask:0xf bank_mask:0x5
    s_nop 1
    v_add_f32_dpp v27, v25, v25 row_half_mirror row_mask:0xf bank_mask:0xa
    v_add_f32_dpp v30, v26, v26 quad_perm:[2,3,0,1] row_mask:0xf bank_mask:0xf
    s_nop 0
    v_add_f32_dpp v31, v27, v27 quad_perm:[2,3,0,1] row_mask:0xf bank_mask:0xf
    v_cndmask_b32 v28, v30, v31, s[58:59]
    v_dot2_f32_bf16 v22, v128, v6, 0
    v_dot2_f32_bf16 v22, v129, v7, v22
    v_dot2_f32_bf16 v22, v130, v8, v22
    v_dot2_f32_bf16 v22, v131, v9, v22
    v_xor_b32 v207, 6865920, v206
    s_waitcnt vmcnt(4)
    buffer_load_dwordx4 v[128:131], v207, s[28:31], 0 offen nt
    v_dot2_f32_bf16 v23, v132, v6, 0
    v_dot2_f32_bf16 v23, v133, v7, v23
    v_dot2_f32_bf16 v23, v134, v8, v23
    v_dot2_f32_bf16 v23, v135, v9, v23
    v_xor_b32 v207, 6939648, v206
    s_waitcnt vmcnt(4)
    buffer_load_dwordx4 v[132:135], v207, s[28:31], 0 offen nt
    v_add_f32_dpp v24, v22, v22 row_ror:8 row_mask:0xf bank_mask:0x3
    s_nop 1
    v_add_f32_dpp v24, v23, v23 row_ror:8 row_mask:0xf bank_mask:0xc
    v_dot2_f32_bf16 v22, v136, v6, 0
    v_dot2_f32_bf16 v22, v137, v7, v22
    v_dot2_f32_bf16 v22, v138, v8, v22
    v_dot2_f32_bf16 v22, v139, v9, v22
    v_xor_b32 v207, 2672128, v206
    s_waitcnt vmcnt(4)
    buffer_load_dwordx4 v[136:139], v207, s[28:31], 0 offen nt
    v_dot2_f32_bf16 v23, v140, v6, 0
    v_dot2_f32_bf16 v23, v141, v7, v23
    v_dot2_f32_bf16 v23, v142, v8, v23
    v_dot2_f32_bf16 v23, v143, v9, v23
    v_xor_b32 v207, 2745856, v206
    s_waitcnt vmcnt(4)
    buffer_load_dwordx4 v[140:143], v207, s[28:31], 0 offen nt
    v_add_f32_dpp v25, v22, v22 row_ror:8 row_mask:0xf bank_mask:0x3
    s_nop 1
    v_add_f32_dpp v25, v23, v23 row_ror:8 row_mask:0xf bank_mask:0xc
    v_add_f32_dpp v26, v24, v24 row_half_mirror row_mask:0xf bank_mask:0x5
    s_nop 1
    v_add_f32_dpp v26, v25, v25 row_half_mirror row_mask:0xf bank_mask:0xa
    v_dot2_f32_bf16 v22, v144, v6, 0
    v_dot2_f32_bf16 v22, v145, v7, v22
    v_dot2_f32_bf16 v22, v146, v8, v22
    v_dot2_f32_bf16 v22, v147, v9, v22
    v_xor_b32 v207, 6980608, v206
    s_waitcnt vmcnt(4)
    buffer_load_dwordx4 v[144:147], v207, s[28:31], 0 offen nt
    v_dot2_f32_bf16 v23, v148, v6, 0
    v_dot2_f32_bf16 v23, v149, v7, v23
    v_dot2_f32_bf16 v23, v150, v8, v23
    v_dot2_f32_bf16 v23, v151, v9, v23
    v_xor_b32 v207, 7054336, v206
    s_waitcnt vmcnt(4)
    buffer_load_dwordx4 v[148:151], v207, s[28:31], 0 offen nt
    v_add_f32_dpp v24, v22, v22 row_ror:8 row_mask:0xf bank_mask:0x3
    s_nop 1
    v_add_f32_dpp v24, v23, v23 row_ror:8 row_mask:0xf bank_mask:0xc
    v_dot2_f32_bf16 v22, v152, v6, 0
    v_dot2_f32_bf16 v22, v153, v7, v22
    v_dot2_f32_bf16 v22, v154, v8, v22
    v_dot2_f32_bf16 v22, v155, v9, v22
    v_xor_b32 v207, 2786816, v206
    s_waitcnt vmcnt(4)
    buffer_load_dwordx4 v[152:155], v207, s[28:31], 0 offen nt
    v_dot2_f32_bf16 v23, v156, v6, 0
    v_dot2_f32_bf16 v23, v157, v7, v23
    v_dot2_f32_bf16 v23, v158, v8, v23
    v_dot2_f32_bf16 v23, v159, v9, v23
    v_xor_b32 v207, 2860544, v206
    s_waitcnt vmcnt(4)
    buffer_load_dwordx4 v[156:159], v207, s[28:31], 0 offen nt
    v_add_f32_dpp v25, v22, v22 row_ror:8 row_mask:0xf bank_mask:0x3
    s_nop 1
    v_add_f32_dpp v25, v23, v23 row_ror:8 row_mask:0xf bank_mask:0xc
    v_add_f32_dpp v27, v24, v24 row_half_mirror row_mask:0xf bank_mask:0x5
    s_nop 1
    v_add_f32_dpp v27, v25, v25 row_half_mirror row_mask:0xf bank_mask:0xa
    v_add_f32_dpp v30, v26, v26 quad_perm:[2,3,0,1] row_mask:0xf bank_mask:0xf
    s_nop 0
    v_add_f32_dpp v31, v27, v27 quad_perm:[2,3,0,1] row_mask:0xf bank_mask:0xf
    v_cndmask_b32 v29, v30, v31, s[58:59]
    v_add_f32_dpp v30, v28, v28 quad_perm:[1,0,3,2] row_mask:0xf bank_mask:0xf
    s_nop 0
    v_add_f32_dpp v31, v29, v29 quad_perm:[1,0,3,2] row_mask:0xf bank_mask:0xf
    v_cndmask_b32 v5, v30, v31, s[60:61]
    v_cvt_pk_bf16_f32 v5, 0, v5
    v_mul_f32 v5, s63, v5
    v_cvt_pk_bf16_f32 v5, 0, v5
    ds_write_b64 v20, v[4:5] offset:37632
    v_max3_f32 v18, v4, v5, v18
    v_add_u32 v20, 512, v20
    s_add_u32 s56, s56, 1
    s_barrier
    s_cmp_lt_u32 s56, 8
    s_cbranch_scc1 L_kloop
    v_subrev_u32 v20, 4096, v20
    ds_read_b64 v[4:5], v20 offset:37632
    v_max_f32_dpp v18, v18, v18 row_ror:8 row_mask:0xf bank_mask:0xf
    s_nop 1
    v_max_f32_dpp v18, v18, v18 row_ror:4 row_mask:0xf bank_mask:0xf
    s_nop 1
    v_max_f32_dpp v18, v18, v18 row_ror:2 row_mask:0xf bank_mask:0xf
    s_nop 1
    v_max_f32_dpp v18, v18, v18 row_ror:1 row_mask:0xf bank_mask:0xf
    v_mov_b32 v30, v18
    s_nop 1
    v_permlane16_swap_b32 v18, v30
    v_max_f32 v18, v18, v30
    v_mov_b32 v30, v18
    s_nop 1
    v_permlane32_swap_b32 v18, v30
    v_max_f32 v18, v18, v30
    s_mov_b32 s56, 0
L_vloop:
    s_mov_b32 s54, s32
    s_bitcmp1_b32 s33, 0
    s_cselect_b32 s35, 7079936, 0
    s_xor_b32 s54, s54, s35
    s_bitcmp1_b32 s33, 1
    s_cselect_b32 s35, 4718592, 0
    s_xor_b32 s54, s54, s35
    s_bitcmp1_b32 s33, 2
    s_cselect_b32 s35, 5374464, 0
    s_xor_b32 s54, s54, s35
    s_add_u32 s33, s33, 1
    v_xor_b32 v206, s54, v3
    s_waitcnt lgkmcnt(0)
    v_sub_f32 v26, v4, v18
    v_sub_f32 v27, v5, v18
    v_mul_f32 v26, s62, v26
    v_mul_f32 v27, s62, v27
    v_exp_f32 v26, v26
    v_exp_f32 v27, v27
    v_cvt_pk_bf16_f32 v23, 0, v26
    v_cvt_pk_bf16_f32 v22, v26, 0
    v_cvt_pk_bf16_f32 v25, 0, v27
    v_cvt_pk_bf16_f32 v24, v27, 0
    v_add_f32 v19, v19, v23
    v_add_f32 v19, v19, v25
    v_add_u32 v20, 512, v20
    ds_read_b64 v[4:5], v20 offset:37632
    s_cmp_ge_u32 s56, 6
    v_dot2c_f32_bf16_dpp v10, v22, v32 row_newbcast:0 row_mask:0xf bank_mask:0xf
    v_dot2c_f32_bf16_dpp v11, v23, v32 row_newbcast:0 row_mask:0xf bank_mask:0xf
    v_dot2c_f32_bf16_dpp v12, v22, v33 row_newbcast:0 row_mask:0xf bank_mask:0xf
    v_dot2c_f32_bf16_dpp v13, v23, v33 row_newbcast:0 row_mask:0xf bank_mask:0xf
    v_dot2c_f32_bf16_dpp v14, v22, v34 row_newbcast:0 row_mask:0xf bank_mask:0xf
    v_dot2c_f32_bf16_dpp v15, v23, v34 row_newbcast:0 row_mask:0xf bank_mask:0xf
    v_dot2c_f32_bf16_dpp v16, v22, v35 row_newbcast:0 row_mask:0xf bank_mask:0xf
    v_dot2c_f32_bf16_dpp v17, v23, v35 row_newbcast:0 row_mask:0xf bank_mask:0xf
    s_cbranch_scc1 L_p0
    s_waitcnt vmcnt(4)
L_p0:
    s_waitcnt vmcnt(30)
    buffer_load_dwordx4 v[32:35], v206, s[28:31], 0 offen nt
    v_dot2c_f32_bf16_dpp v10, v22, v36 row_newbcast:8 row_mask:0xf bank_mask:0xf
    v_dot2c_f32_bf16_dpp v11, v23, v36 row_newbcast:8 row_mask:0xf bank_mask:0xf
    v_dot2c_f32_bf16_dpp v12, v22, v37 row_newbcast:8 row_mask:0xf bank_mask:0xf
    v_dot2c_f32_bf16_dpp v13, v23, v37 row_newbcast:8 row_mask:0xf bank_mask:0xf
    v_dot2c_f32_bf16_dpp v14, v22, v38 row_newbcast:8 row_mask:0xf bank_mask:0xf
    v_dot2c_f32_bf16_dpp v15, v23, v38 row_newbcast:8 row_mask:0xf bank_mask:0xf
    v_dot2c_f32_bf16_dpp v16, v22, v39 row_newbcast:8 row_mask:0xf bank_mask:0xf
    v_dot2c_f32_bf16_dpp v17, v23, v39 row_newbcast:8 row_mask:0xf bank_mask:0xf
    v_xor_b32 v207, 73728, v206
    s_cbranch_scc1 L_p1
    s_waitcnt vmcnt(4)
L_p1:
    s_waitcnt vmcnt(30)
    buffer_load_dwordx4 v[36:39], v207, s[28:31], 0 offen nt
    v_dot2c_f32_bf16_dpp v10, v22, v40 row_newbcast:4 row_mask:0xf bank_mask:0xf
    v_dot2c_f32_bf16_dpp v11, v23, v40 row_newbcast:4 row_mask:0xf bank_mask:0xf
    v_dot2c_f32_bf16_dpp v12, v22, v41 row_newbcast:4 row_mask:0xf bank_mask:0xf
    v_dot2c_f32_bf16_dpp v13, v23, v41 row_newbcast:4 row_mask:0xf bank_mask:0xf
    v_dot2c_f32_bf16_dpp v14, v22, v42 row_newbcast:4 row_mask:0xf bank_mask:0xf
    v_dot2c_f32_bf16_dpp v15, v23, v42 row_newbcast:4 row_mask:0xf bank_mask:0xf
    v_dot2c_f32_bf16_dpp v16, v22, v43 row_newbcast:4 row_mask:0xf bank_mask:0xf
    v_dot2c_f32_bf16_dpp v17, v23, v43 row_newbcast:4 row_mask:0xf bank_mask:0xf
    v_xor_b32 v207, 4194816, v206
    s_cbranch_scc1 L_p2
    s_waitcnt vmcnt(4)
L_p2:
    s_waitcnt vmcnt(30)
    buffer_load_dwordx4 v[40:43], v207, s[28:31], 0 offen nt
    v_dot2c_f32_bf16_dpp v10, v22, v44 row_newbcast:12 row_mask:0xf bank_mask:0xf
    v_dot2c_f32_bf16_dpp v11, v23, v44 row_newbcast:12 row_mask:0xf bank_mask:0xf
    v_dot2c_f32_bf16_dpp v12, v22, v45 row_newbcast:12 row_mask:0xf bank_mask:0xf
    v_dot2c_f32_bf16_dpp v13, v23, v45 row_newbcast:12 row_mask:0xf bank_mask:0xf
    v_dot2c_f32_bf16_dpp v14, v22, v46 row_newbcast:12 row_mask:0xf bank_mask:0xf
    v_dot2c_f32_bf16_dpp v15, v23, v46 row_newbcast:12 row_mask:0xf bank_mask:0xf
    v_dot2c_f32_bf16_dpp v16, v22, v47 row_newbcast:12 row_mask:0xf bank_mask:0xf
    v_dot2c_f32_bf16_dpp v17, v23, v47 row_newbcast:12 row_mask:0xf bank_mask:0xf
    v_xor_b32 v207, 4268544, v206
    s_cbranch_scc1 L_p3
    s_waitcnt vmcnt(4)
L_p3:
    s_waitcnt vmcnt(30)
    buffer_load_dwordx4 v[44:47], v207, s[28:31], 0 offen nt
    v_dot2c_f32_bf16_dpp v10, v22, v48 row_newbcast:2 row_mask:0xf bank_mask:0xf
    v_dot2c_f32_bf16_dpp v11, v23, v48 row_newbcast:2 row_mask:0xf bank_mask:0xf
    v_dot2c_f32_bf16_dpp v12, v22, v49 row_newbcast:2 row_mask:0xf bank_mask:0xf
    v_dot2c_f32_bf16_dpp v13, v23, v49 row_newbcast:2 row_mask:0xf bank_mask:0xf
    v_dot2c_f32_bf16_dpp v14, v22, v50 row_newbcast:2 row_mask:0xf bank_mask:0xf
    v_dot2c_f32_bf16_dpp v15, v23, v50 row_newbcast:2 row_mask:0xf bank_mask:0xf
    v_dot2c_f32_bf16_dpp v16, v22, v51 row_newbcast:2 row_mask:0xf bank_mask:0xf
    v_dot2c_f32_bf16_dpp v17, v23, v51 row_newbcast:2 row_mask:0xf bank_mask:0xf
    v_xor_b32 v207, 147456, v206
    s_cbranch_scc1 L_p4
    s_waitcnt vmcnt(4)
L_p4:
    s_waitcnt vmcnt(30)
    buffer_load_dwordx4 v[48:51], v207, s[28:31], 0 offen nt
    v_dot2c_f32_bf16_dpp v10, v22, v52 row_newbcast:10 row_mask:0xf bank_mask:0xf
    v_dot2c_f32_bf16_dpp v11, v23, v52 row_newbcast:10 row_mask:0xf bank_mask:0xf
    v_dot2c_f32_bf16_dpp v12, v22, v53 row_newbcast:10 row_mask:0xf bank_mask:0xf
    v_dot2c_f32_bf16_dpp v13, v23, v53 row_newbcast:10 row_mask:0xf bank_mask:0xf
    v_dot2c_f32_bf16_dpp v14, v22, v54 row_newbcast:10 row_mask:0xf bank_mask:0xf
    v_dot2c_f32_bf16_dpp v15, v23, v54 row_newbcast:10 row_mask:0xf bank_mask:0xf
    v_dot2c_f32_bf16_dpp v16, v22, v55 row_newbcast:10 row_mask:0xf bank_mask:0xf
    v_dot2c_f32_bf16_dpp v17, v23, v55 row_newbcast:10 row_mask:0xf bank_mask:0xf
    v_xor_b32 v207, 221184, v206
    s_cbranch_scc1 L_p5
    s_waitcnt vmcnt(4)
L_p5:
    s_waitcnt vmcnt(30)
    buffer_load_dwordx4 v[52:55], v207, s[28:31], 0 offen nt
    v_dot2c_f32_bf16_dpp v10, v22, v56 row_newbcast:6 row_mask:0xf bank_mask:0xf
    v_dot2c_f32_bf16_dpp v11, v23, v56 row_newbcast:6 row_mask:0xf bank_mask:0xf
    v_dot2c_f32_bf16_dpp v12, v22, v57 row_newbcast:6 row_mask:0xf bank_mask:0xf
    v_dot2c_f32_bf16_dpp v13, v23, v57 row_newbcast:6 row_mask:0xf bank_mask:0xf
    v_dot2c_f32_bf16_dpp v14, v22, v58 row_newbcast:6 row_mask:0xf bank_mask:0xf
    v_dot2c_f32_bf16_dpp v15, v23, v58 row_newbcast:6 row_mask:0xf bank_mask:0xf
    v_dot2c_f32_bf16_dpp v16, v22, v59 row_newbcast:6 row_mask:0xf bank_mask:0xf
    v_dot2c_f32_bf16_dpp v17, v23, v59 row_newbcast:6 row_mask:0xf bank_mask:0xf
    v_xor_b32 v207, 4342272, v206
    s_cbranch_scc1 L_p6
    s_waitcnt vmcnt(4)
L_p6:
    s_waitcnt vmcnt(30)
    buffer_load_dwordx4 v[56:59], v207, s[28:31], 0 offen nt
    v_dot2c_f32_bf16_dpp v10, v22, v60 row_newbcast:14 row_mask:0xf bank_mask:0xf
    v_dot2c_f32_bf16_dpp v11, v23, v60 row_newbcast:14 row_mask:0xf bank_mask:0xf
    v_dot2c_f32_bf16_dpp v12, v22, v61 row_newbcast:14 row_mask:0xf bank_mask:0xf
    v_dot2c_f32_bf16_dpp v13, v23, v61 row_newbcast:14 row_mask:0xf bank_mask:0xf
    v_dot2c_f32_bf16_dpp v14, v22, v62 row_newbcast:14 row_mask:0xf bank_mask:0xf
    v_dot2c_f32_bf16_dpp v15, v23, v62 row_newbcast:14 row_mask:0xf bank_mask:0xf
    v_dot2c_f32_bf16_dpp v16, v22, v63 row_newbcast:14 row_mask:0xf bank_mask:0xf
    v_dot2c_f32_bf16_dpp v17, v23, v63 row_newbcast:14 row_mask:0xf bank_mask:0xf
    v_xor_b32 v207, 4416000, v206
    s_cbranch_scc1 L_p7
    s_waitcnt vmcnt(4)
L_p7:
    s_waitcnt vmcnt(30)
    buffer_load_dwordx4 v[60:63], v207, s[28:31], 0 offen nt
    v_dot2c_f32_bf16_dpp v10, v22, v64 row_newbcast:1 row_mask:0xf bank_mask:0xf
    v_dot2c_f32_bf16_dpp v11, v23, v64 row_newbcast:1 row_mask:0xf bank_mask:0xf
    v_dot2c_f32_bf16_dpp v12, v22, v65 row_newbcast:1 row_mask:0xf bank_mask:0xf
    v_dot2c_f32_bf16_dpp v13, v23, v65 row_newbcast:1 row_mask:0xf bank_mask:0xf
    v_dot2c_f32_bf16_dpp v14, v22, v66 row_newbcast:1 row_mask:0xf bank_mask:0xf
    v_dot2c_f32_bf16_dpp v15, v23, v66 row_newbcast:1 row_mask:0xf bank_mask:0xf
    v_dot2c_f32_bf16_dpp v16, v22, v67 row_newbcast:1 row_mask:0xf bank_mask:0xf
    v_dot2c_f32_bf16_dpp v17, v23, v67 row_newbcast:1 row_mask:0xf bank_mask:0xf
    v_xor_b32 v207, 180224, v206
    s_cbranch_scc1 L_p8
    s_waitcnt vmcnt(4)
L_p8:
    s_waitcnt vmcnt(30)
    buffer_load_dwordx4 v[64:67], v207, s[28:31], 0 offen nt
    v_dot2c_f32_bf16_dpp v10, v22, v68 row_newbcast:9 row_mask:0xf bank_mask:0xf
    v_dot2c_f32_bf16_dpp v11, v23, v68 row_newbcast:9 row_mask:0xf bank_mask:0xf
    v_dot2c_f32_bf16_dpp v12, v22, v69 row_newbcast:9 row_mask:0xf bank_mask:0xf
    v_dot2c_f32_bf16_dpp v13, v23, v69 row_newbcast:9 row_mask:0xf bank_mask:0xf
    v_dot2c_f32_bf16_dpp v14, v22, v70 row_newbcast:9 row_mask:0xf bank_mask:0xf
    v_dot2c_f32_bf16_dpp v15, v23, v70 row_newbcast:9 row_mask:0xf bank_mask:0xf
    v_dot2c_f32_bf16_dpp v16, v22, v71 row_newbcast:9 row_mask:0xf bank_mask:0xf
    v_dot2c_f32_bf16_dpp v17, v23, v71 row_newbcast:9 row_mask:0xf bank_mask:0xf
    v_xor_b32 v207, 253952, v206
    s_cbranch_scc1 L_p9
    s_waitcnt vmcnt(4)
L_p9:
    s_waitcnt vmcnt(30)
    buffer_load_dwordx4 v[68:71], v207, s[28:31], 0 offen nt
    v_dot2c_f32_bf16_dpp v10, v22, v72 row_newbcast:5 row_mask:0xf bank_mask:0xf
    v_dot2c_f32_bf16_dpp v11, v23, v72 row_newbcast:5 row_mask:0xf bank_mask:0xf
    v_dot2c_f32_bf16_dpp v12, v22, v73 row_newbcast:5 row_mask:0xf bank_mask:0xf
    v_dot2c_f32_bf16_dpp v13, v23, v73 row_newbcast:5 row_mask:0xf bank_mask:0xf
    v_dot2c_f32_bf16_dpp v14, v22, v74 row_newbcast:5 row_mask:0xf bank_mask:0xf
    v_dot2c_f32_bf16_dpp v15, v23, v74 row_newbcast:5 row_mask:0xf bank_mask:0xf
    v_dot2c_f32_bf16_dpp v16, v22, v75 row_newbcast:5 row_mask:0xf bank_mask:0xf
    v_dot2c_f32_bf16_dpp v17, v23, v75 row_newbcast:5 row_mask:0xf bank_mask:0xf
    v_xor_b32 v207, 4375040, v206
    s_cbranch_scc1 L_p10
    s_waitcnt vmcnt(4)
L_p10:
    s_waitcnt vmcnt(30)
    buffer_load_dwordx4 v[72:75], v207, s[28:31], 0 offen nt
    v_dot2c_f32_bf16_dpp v10, v22, v76 row_newbcast:13 row_mask:0xf bank_mask:0xf
    v_dot2c_f32_bf16_dpp v11, v23, v76 row_newbcast:13 row_mask:0xf bank_mask:0xf
    v_dot2c_f32_bf16_dpp v12, v22, v77 row_newbcast:13 row_mask:0xf bank_mask:0xf
    v_dot2c_f32_bf16_dpp v13, v23, v77 row_newbcast:13 row_mask:0xf bank_mask:0xf
    v_dot2c_f32_bf16_dpp v14, v22, v78 row_newbcast:13 row_mask:0xf bank_mask:0xf
    v_dot2c_f32_bf16_dpp v15, v23, v78 row_newbcast:13 row_mask:0xf bank_mask:0xf
    v_dot2c_f32_bf16_dpp v16, v22, v79 row_newbcast:13 row_mask:0xf bank_mask:0xf
    v_dot2c_f32_bf16_dpp v17, v23, v79 row_newbcast:13 row_mask:0xf bank_mask:0xf
    v_xor_b32 v207, 4448768, v206
    s_cbranch_scc1 L_p11
    s_waitcnt vmcnt(4)
L_p11:
    s_waitcnt vmcnt(30)
    buffer_load_dwordx4 v[76:79], v207, s[28:31], 0 offen nt
    v_dot2c_f32_bf16_dpp v10, v22, v80 row_newbcast:3 row_mask:0xf bank_mask:0xf
    v_dot2c_f32_bf16_dpp v11, v23, v80 row_newbcast:3 row_mask:0xf bank_mask:0xf
    v_dot2c_f32_bf16_dpp v12, v22, v81 row_newbcast:3 row_mask:0xf bank_mask:0xf
    v_dot2c_f32_bf16_dpp v13, v23, v81 row_newbcast:3 row_mask:0xf bank_mask:0xf
    v_dot2c_f32_bf16_dpp v14, v22, v82 row_newbcast:3 row_mask:0xf bank_mask:0xf
    v_dot2c_f32_bf16_dpp v15, v23, v82 row_newbcast:3 row_mask:0xf bank_mask:0xf
    v_dot2c_f32_bf16_dpp v16, v22, v83 row_newbcast:3 row_mask:0xf bank_mask:0xf
    v_dot2c_f32_bf16_dpp v17, v23, v83 row_newbcast:3 row_mask:0xf bank_mask:0xf
    v_xor_b32 v207, 32768, v206
    s_cbranch_scc1 L_p12
    s_waitcnt vmcnt(4)
L_p12:
    s_waitcnt vmcnt(30)
    buffer_load_dwordx4 v[80:83], v207, s[28:31], 0 offen nt
    v_dot2c_f32_bf16_dpp v10, v22, v84 row_newbcast:11 row_mask:0xf bank_mask:0xf
    v_dot2c_f32_bf16_dpp v11, v23, v84 row_newbcast:11 row_mask:0xf bank_mask:0xf
    v_dot2c_f32_bf16_dpp v12, v22, v85 row_newbcast:11 row_mask:0xf bank_mask:0xf
    v_dot2c_f32_bf16_dpp v13, v23, v85 row_newbcast:11 row_mask:0xf bank_mask:0xf
    v_dot2c_f32_bf16_dpp v14, v22, v86 row_newbcast:11 row_mask:0xf bank_mask:0xf
    v_dot2c_f32_bf16_dpp v15, v23, v86 row_newbcast:11 row_mask:0xf bank_mask:0xf
    v_dot2c_f32_bf16_dpp v16, v22, v87 row_newbcast:11 row_mask:0xf bank_mask:0xf
    v_dot2c_f32_bf16_dpp v17, v23, v87 row_newbcast:11 row_mask:0xf bank_mask:0xf
    v_xor_b32 v207, 106496, v206
    s_cbranch_scc1 L_p13
    s_waitcnt vmcnt(4)
L_p13:
    s_waitcnt vmcnt(30)
    buffer_load_dwordx4 v[84:87], v207, s[28:31], 0 offen nt
    v_dot2c_f32_bf16_dpp v10, v22, v88 row_newbcast:7 row_mask:0xf bank_mask:0xf
    v_dot2c_f32_bf16_dpp v11, v23, v88 row_newbcast:7 row_mask:0xf bank_mask:0xf
    v_dot2c_f32_bf16_dpp v12, v22, v89 row_newbcast:7 row_mask:0xf bank_mask:0xf
    v_dot2c_f32_bf16_dpp v13, v23, v89 row_newbcast:7 row_mask:0xf bank_mask:0xf
    v_dot2c_f32_bf16_dpp v14, v22, v90 row_newbcast:7 row_mask:0xf bank_mask:0xf
    v_dot2c_f32_bf16_dpp v15, v23, v90 row_newbcast:7 row_mask:0xf bank_mask:0xf
    v_dot2c_f32_bf16_dpp v16, v22, v91 row_newbcast:7 row_mask:0xf bank_mask:0xf
    v_dot2c_f32_bf16_dpp v17, v23, v91 row_newbcast:7 row_mask:0xf bank_mask:0xf
    v_xor_b32 v207, 4227584, v206
    s_cbranch_scc1 L_p14
    s_waitcnt vmcnt(4)
L_p14:
    s_waitcnt vmcnt(30)
    buffer_load_dwordx4 v[88:91], v207, s[28:31], 0 offen nt
    v_dot2c_f32_bf16_dpp v10, v22, v92 row_newbcast:15 row_mask:0xf bank_mask:0xf
    v_dot2c_f32_bf16_dpp v11, v23, v92 row_newbcast:15 row_mask:0xf bank_mask:0xf
    v_dot2c_f32_bf16_dpp v12, v22, v93 row_newbcast:15 row_mask:0xf bank_mask:0xf
    v_dot2c_f32_bf16_dpp v13, v23, v93 row_newbcast:15 row_mask:0xf bank_mask:0xf
    v_dot2c_f32_bf16_dpp v14, v22, v94 row_newbcast:15 row_mask:0xf bank_mask:0xf
    v_dot2c_f32_bf16_dpp v15, v23, v94 row_newbcast:15 row_mask:0xf bank_mask:0xf
    v_dot2c_f32_bf16_dpp v16, v22, v95 row_newbcast:15 row_mask:0xf bank_mask:0xf
    v_dot2c_f32_bf16_dpp v17, v23, v95 row_newbcast:15 row_mask:0xf bank_mask:0xf
    v_xor_b32 v207, 4301312, v206
    s_cbranch_scc1 L_p15
    s_waitcnt vmcnt(4)
L_p15:
    s_waitcnt vmcnt(30)
    buffer_load_dwordx4 v[92:95], v207, s[28:31], 0 offen nt
    v_dot2c_f32_bf16_dpp v10, v24, v96 row_newbcast:0 row_mask:0xf bank_mask:0xf
    v_dot2c_f32_bf16_dpp v11, v25, v96 row_newbcast:0 row_mask:0xf bank_mask:0xf
    v_dot2c_f32_bf16_dpp v12, v24, v97 row_newbcast:0 row_mask:0xf bank_mask:0xf
    v_dot2c_f32_bf16_dpp v13, v25, v97 row_newbcast:0 row_mask:0xf bank_mask:0xf
    v_dot2c_f32_bf16_dpp v14, v24, v98 row_newbcast:0 row_mask:0xf bank_mask:0xf
    v_dot2c_f32_bf16_dpp v15, v25, v98 row_newbcast:0 row_mask:0xf bank_mask:0xf
    v_dot2c_f32_bf16_dpp v16, v24, v99 row_newbcast:0 row_mask:0xf bank_mask:0xf
    v_dot2c_f32_bf16_dpp v17, v25, v99 row_newbcast:0 row_mask:0xf bank_mask:0xf
    v_xor_b32 v207, 6947840, v206
    s_cbranch_scc1 L_p16
    s_waitcnt vmcnt(4)
L_p16:
    s_waitcnt vmcnt(30)
    buffer_load_dwordx4 v[96:99], v207, s[28:31], 0 offen nt
    v_dot2c_f32_bf16_dpp v10, v24, v100 row_newbcast:8 row_mask:0xf bank_mask:0xf
    v_dot2c_f32_bf16_dpp v11, v25, v100 row_newbcast:8 row_mask:0xf bank_mask:0xf
    v_dot2c_f32_bf16_dpp v12, v24, v101 row_newbcast:8 row_mask:0xf bank_mask:0xf
    v_dot2c_f32_bf16_dpp v13, v25, v101 row_newbcast:8 row_mask:0xf bank_mask:0xf
    v_dot2c_f32_bf16_dpp v14, v24, v102 row_newbcast:8 row_mask:0xf bank_mask:0xf
    v_dot2c_f32_bf16_dpp v15, v25, v102 row_newbcast:8 row_mask:0xf bank_mask:0xf
    v_dot2c_f32_bf16_dpp v16, v24, v103 row_newbcast:8 row_mask:0xf bank_mask:0xf
    v_dot2c_f32_bf16_dpp v17, v25, v103 row_newbcast:8 row_mask:0xf bank_mask:0xf
    v_xor_b32 v207, 7021568, v206
    s_cbranch_scc1 L_p17
    s_waitcnt vmcnt(4)
L_p17:
    s_waitcnt vmcnt(30)
    buffer_load_dwordx4 v[100:103], v207, s[28:31], 0 offen nt
    v_dot2c_f32_bf16_dpp v10, v24, v104 row_newbcast:4 row_mask:0xf bank_mask:0xf
    v_dot2c_f32_bf16_dpp v11, v25, v104 row_newbcast:4 row_mask:0xf bank_mask:0xf
    v_dot2c_f32_bf16_dpp v12, v24, v105 row_newbcast:4 row_mask:0xf bank_mask:0xf
    v_dot2c_f32_bf16_dpp v13, v25, v105 row_newbcast:4 row_mask:0xf bank_mask:0xf
    v_dot2c_f32_bf16_dpp v14, v24, v106 row_newbcast:4 row_mask:0xf bank_mask:0xf
    v_dot2c_f32_bf16_dpp v15, v25, v106 row_newbcast:4 row_mask:0xf bank_mask:0xf
    v_dot2c_f32_bf16_dpp v16, v24, v107 row_newbcast:4 row_mask:0xf bank_mask:0xf
    v_dot2c_f32_bf16_dpp v17, v25, v107 row_newbcast:4 row_mask:0xf bank_mask:0xf
    v_xor_b32 v207, 2754048, v206
    s_cbranch_scc1 L_p18
    s_waitcnt vmcnt(4)
L_p18:
    s_waitcnt vmcnt(30)
    buffer_load_dwordx4 v[104:107], v207, s[28:31], 0 offen nt
    v_dot2c_f32_bf16_dpp v10, v24, v108 row_newbcast:12 row_mask:0xf bank_mask:0xf
    v_dot2c_f32_bf16_dpp v11, v25, v108 row_newbcast:12 row_mask:0xf bank_mask:0xf
    v_dot2c_f32_bf16_dpp v12, v24, v109 row_newbcast:12 row_mask:0xf bank_mask:0xf
    v_dot2c_f32_bf16_dpp v13, v25, v109 row_newbcast:12 row_mask:0xf bank_mask:0xf
    v_dot2c_f32_bf16_dpp v14, v24, v110 row_newbcast:12 row_mask:0xf bank_mask:0xf
    v_dot2c_f32_bf16_dpp v15, v25, v110 row_newbcast:12 row_mask:0xf bank_mask:0xf
    v_dot2c_f32_bf16_dpp v16, v24, v111 row_newbcast:12 row_mask:0xf bank_mask:0xf
    v_dot2c_f32_bf16_dpp v17, v25, v111 row_newbcast:12 row_mask:0xf bank_mask:0xf
    v_xor_b32 v207, 2827776, v206
    s_cbranch_scc1 L_p19
    s_waitcnt vmcnt(4)
L_p19:
    s_waitcnt vmcnt(30)
    buffer_load_dwordx4 v[108:111], v207, s[28:31], 0 offen nt
    v_dot2c_f32_bf16_dpp v10, v24, v112 row_newbcast:2 row_mask:0xf bank_mask:0xf
    v_dot2c_f32_bf16_dpp v11, v25, v112 row_newbcast:2 row_mask:0xf bank_mask:0xf
    v_dot2c_f32_bf16_dpp v12, v24, v113 row_newbcast:2 row_mask:0xf bank_mask:0xf
    v_dot2c_f32_bf16_dpp v13, v25, v113 row_newbcast:2 row_mask:0xf bank_mask:0xf
    v_dot2c_f32_bf16_dpp v14, v24, v114 row_newbcast:2 row_mask:0xf bank_mask:0xf
    v_dot2c_f32_bf16_dpp v15, v25, v114 row_newbcast:2 row_mask:0xf bank_mask:0xf
    v_dot2c_f32_bf16_dpp v16, v24, v115 row_newbcast:2 row_mask:0xf bank_mask:0xf
    v_dot2c_f32_bf16_dpp v17, v25, v115 row_newbcast:2 row_mask:0xf bank_mask:0xf
    v_xor_b32 v207, 6833152, v206
    s_cbranch_scc1 L_p20
    s_waitcnt vmcnt(4)
L_p20:
    s_waitcnt vmcnt(30)
    buffer_load_dwordx4 v[112:115], v207, s[28:31], 0 offen nt
    v_dot2c_f32_bf16_dpp v10, v24, v116 row_newbcast:10 row_mask:0xf bank_mask:0xf
    v_dot2c_f32_bf16_dpp v11, v25, v116 row_newbcast:10 row_mask:0xf bank_mask:0xf
    v_dot2c_f32_bf16_dpp v12, v24, v117 row_newbcast:10 row_mask:0xf bank_mask:0xf
    v_dot2c_f32_bf16_dpp v13, v25, v117 row_newbcast:10 row_mask:0xf bank_mask:0xf
    v_dot2c_f32_bf16_dpp v14, v24, v118 row_newbcast:10 row_mask:0xf bank_mask:0xf
    v_dot2c_f32_bf16_dpp v15, v25, v118 row_newbcast:10 row_mask:0xf bank_mask:0xf
    v_dot2c_f32_bf16_dpp v16, v24, v119 row_newbcast:10 row_mask:0xf bank_mask:0xf
    v_dot2c_f32_bf16_dpp v17, v25, v119 row_newbcast:10 row_mask:0xf bank_mask:0xf
    v_xor_b32 v207, 6906880, v206
    s_cbranch_scc1 L_p21
    s_waitcnt vmcnt(4)
L_p21:
    s_waitcnt vmcnt(30)
    buffer_load_dwordx4 v[116:119], v207, s[28:31], 0 offen nt
    v_dot2c_f32_bf16_dpp v10, v24, v120 row_newbcast:6 row_mask:0xf bank_mask:0xf
    v_dot2c_f32_bf16_dpp v11, v25, v120 row_newbcast:6 row_mask:0xf bank_mask:0xf
    v_dot2c_f32_bf16_dpp v12, v24, v121 row_newbcast:6 row_mask:0xf bank_mask:0xf
    v_dot2c_f32_bf16_dpp v13, v25, v121 row_newbcast:6 row_mask:0xf bank_mask:0xf
    v_dot2c_f32_bf16_dpp v14, v24, v122 row_newbcast:6 row_mask:0xf bank_mask:0xf
    v_dot2c_f32_bf16_dpp v15, v25, v122 row_newbcast:6 row_mask:0xf bank_mask:0xf
    v_dot2c_f32_bf16_dpp v16, v24, v123 row_newbcast:6 row_mask:0xf bank_mask:0xf
    v_dot2c_f32_bf16_dpp v17, v25, v123 row_newbcast:6 row_mask:0xf bank_mask:0xf
    v_xor_b32 v207, 2639360, v206
    s_cbranch_scc1 L_p22
    s_waitcnt vmcnt(4)
L_p22:
    s_waitcnt vmcnt(30)
    buffer_load_dwordx4 v[120:123], v207, s[28:31], 0 offen nt
    v_dot2c_f32_bf16_dpp v10, v24, v124 row_newbcast:14 row_mask:0xf bank_mask:0xf
    v_dot2c_f32_bf16_dpp v11, v25, v124 row_newbcast:14 row_mask:0xf bank_mask:0xf
    v_dot2c_f32_bf16_dpp v12, v24, v125 row_newbcast:14 row_mask:0xf bank_mask:0xf
    v_dot2c_f32_bf16_dpp v13, v25, v125 row_newbcast:14 row_mask:0xf bank_mask:0xf
    v_dot2c_f32_bf16_dpp v14, v24, v126 row_newbcast:14 row_mask:0xf bank_mask:0xf
    v_dot2c_f32_bf16_dpp v15, v25, v126 row_newbcast:14 row_mask:0xf bank_mask:0xf
    v_dot2c_f32_bf16_dpp v16, v24, v127 row_newbcast:14 row_mask:0xf bank_mask:0xf
    v_dot2c_f32_bf16_dpp v17, v25, v127 row_newbcast:14 row_mask:0xf bank_mask:0xf
    v_xor_b32 v207, 2713088, v206
    s_cbranch_scc1 L_p23
    s_waitcnt vmcnt(4)
L_p23:
    s_waitcnt vmcnt(30)
    buffer_load_dwordx4 v[124:127], v207, s[28:31], 0 offen nt
    v_dot2c_f32_bf16_dpp v10, v24, v128 row_newbcast:1 row_mask:0xf bank_mask:0xf
    v_dot2c_f32_bf16_dpp v11, v25, v128 row_newbcast:1 row_mask:0xf bank_mask:0xf
    v_dot2c_f32_bf16_dpp v12, v24, v129 row_newbcast:1 row_mask:0xf bank_mask:0xf
    v_dot2c_f32_bf16_dpp v13, v25, v129 row_newbcast:1 row_mask:0xf bank_mask:0xf
    v_dot2c_f32_bf16_dpp v14, v24, v130 row_newbcast:1 row_mask:0xf bank_mask:0xf
    v_dot2c_f32_bf16_dpp v15, v25, v130 row_newbcast:1 row_mask:0xf bank_mask:0xf
    v_dot2c_f32_bf16_dpp v16, v24, v131 row_newbcast:1 row_mask:0xf bank_mask:0xf
    v_dot2c_f32_bf16_dpp v17, v25, v131 row_newbcast:1 row_mask:0xf bank_mask:0xf
    v_xor_b32 v207, 6865920, v206
    s_cbranch_scc1 L_p24
    s_waitcnt vmcnt(4)
L_p24:
    s_waitcnt vmcnt(30)
    buffer_load_dwordx4 v[128:131], v207, s[28:31], 0 offen nt
    v_dot2c_f32_bf16_dpp v10, v24, v132 row_newbcast:9 row_mask:0xf bank_mask:0xf
    v_dot2c_f32_bf16_dpp v11, v25, v132 row_newbcast:9 row_mask:0xf bank_mask:0xf
    v_dot2c_f32_bf16_dpp v12, v24, v133 row_newbcast:9 row_mask:0xf bank_mask:0xf
    v_dot2c_f32_bf16_dpp v13, v25, v133 row_newbcast:9 row_mask:0xf bank_mask:0xf
    v_dot2c_f32_bf16_dpp v14, v24, v134 row_newbcast:9 row_mask:0xf bank_mask:0xf
    v_dot2c_f32_bf16_dpp v15, v25, v134 row_newbcast:9 row_mask:0xf bank_mask:0xf
    v_dot2c_f32_bf16_dpp v16, v24, v135 row_newbcast:9 row_mask:0xf bank_mask:0xf
    v_dot2c_f32_bf16_dpp v17, v25, v135 row_newbcast:9 row_mask:0xf bank_mask:0xf
    v_xor_b32 v207, 6939648, v206
    s_cbranch_scc1 L_p25
    s_waitcnt vmcnt(4)
L_p25:
    s_waitcnt vmcnt(30)
    buffer_load_dwordx4 v[132:135], v207, s[28:31], 0 offen nt
    v_dot2c_f32_bf16_dpp v10, v24, v136 row_newbcast:5 row_mask:0xf bank_mask:0xf
    v_dot2c_f32_bf16_dpp v11, v25, v136 row_newbcast:5 row_mask:0xf bank_mask:0xf
    v_dot2c_f32_bf16_dpp v12, v24, v137 row_newbcast:5 row_mask:0xf bank_mask:0xf
    v_dot2c_f32_bf16_dpp v13, v25, v137 row_newbcast:5 row_mask:0xf bank_mask:0xf
    v_dot2c_f32_bf16_dpp v14, v24, v138 row_newbcast:5 row_mask:0xf bank_mask:0xf
    v_dot2c_f32_bf16_dpp v15, v25, v138 row_newbcast:5 row_mask:0xf bank_mask:0xf
    v_dot2c_f32_bf16_dpp v16, v24, v139 row_newbcast:5 row_mask:0xf bank_mask:0xf
    v_dot2c_f32_bf16_dpp v17, v25, v139 row_newbcast:5 row_mask:0xf bank_mask:0xf
    v_xor_b32 v207, 2672128, v206
    s_cbranch_scc1 L_p26
    s_waitcnt vmcnt(4)
L_p26:
    s_waitcnt vmcnt(30)
    buffer_load_dwordx4 v[136:139], v207, s[28:31], 0 offen nt
    v_dot2c_f32_bf16_dpp v10, v24, v140 row_newbcast:13 row_mask:0xf bank_mask:0xf
    v_dot2c_f32_bf16_dpp v11, v25, v140 row_newbcast:13 row_mask:0xf bank_mask:0xf
    v_dot2c_f32_bf16_dpp v12, v24, v141 row_newbcast:13 row_mask:0xf bank_mask:0xf
    v_dot2c_f32_bf16_dpp v13, v25, v141 row_newbcast:13 row_mask:0xf bank_mask:0xf
    v_dot2c_f32_bf16_dpp v14, v24, v142 row_newbcast:13 row_mask:0xf bank_mask:0xf
    v_dot2c_f32_bf16_dpp v15, v25, v142 row_newbcast:13 row_mask:0xf bank_mask:0xf
    v_dot2c_f32_bf16_dpp v16, v24, v143 row_newbcast:13 row_mask:0xf bank_mask:0xf
    v_dot2c_f32_bf16_dpp v17, v25, v143 row_newbcast:13 row_mask:0xf bank_mask:0xf
    v_xor_b32 v207, 2745856, v206
    s_cbranch_scc1 L_p27
    s_waitcnt vmcnt(4)
L_p27:
    s_waitcnt vmcnt(30)
    buffer_load_dwordx4 v[140:143], v207, s[28:31], 0 offen nt
    v_dot2c_f32_bf16_dpp v10, v24, v144 row_newbcast:3 row_mask:0xf bank_mask:0xf
    v_dot2c_f32_bf16_dpp v11, v25, v144 row_newbcast:3 row_mask:0xf bank_mask:0xf
    v_dot2c_f32_bf16_dpp v12, v24, v145 row_newbcast:3 row_mask:0xf bank_mask:0xf
    v_dot2c_f32_bf16_dpp v13, v25, v145 row_newbcast:3 row_mask:0xf bank_mask:0xf
    v_dot2c_f32_bf16_dpp v14, v24, v146 row_newbcast:3 row_mask:0xf bank_mask:0xf
    v_dot2c_f32_bf16_dpp v15, v25, v146 row_newbcast:3 row_mask:0xf bank_mask:0xf
    v_dot2c_f32_bf16_dpp v16, v24, v147 row_newbcast:3 row_mask:0xf bank_mask:0xf
    v_dot2c_f32_bf16_dpp v17, v25, v147 row_newbcast:3 row_mask:0xf bank_mask:0xf
    v_xor_b32 v207, 6980608, v206
    s_cbranch_scc1 L_p28
    s_waitcnt vmcnt(4)
L_p28:
    s_waitcnt vmcnt(30)
    buffer_load_dwordx4 v[144:147], v207, s[28:31], 0 offen nt
    v_dot2c_f32_bf16_dpp v10, v24, v148 row_newbcast:11 row_mask:0xf bank_mask:0xf
    v_dot2c_f32_bf16_dpp v11, v25, v148 row_newbcast:11 row_mask:0xf bank_mask:0xf
    v_dot2c_f32_bf16_dpp v12, v24, v149 row_newbcast:11 row_mask:0xf bank_mask:0xf
    v_dot2c_f32_bf16_dpp v13, v25, v149 row_newbcast:11 row_mask:0xf bank_mask:0xf
    v_dot2c_f32_bf16_dpp v14, v24, v150 row_newbcast:11 row_mask:0xf bank_mask:0xf
    v_dot2c_f32_bf16_dpp v15, v25, v150 row_newbcast:11 row_mask:0xf bank_mask:0xf
    v_dot2c_f32_bf16_dpp v16, v24, v151 row_newbcast:11 row_mask:0xf bank_mask:0xf
    v_dot2c_f32_bf16_dpp v17, v25, v151 row_newbcast:11 row_mask:0xf bank_mask:0xf
    v_xor_b32 v207, 7054336, v206
    s_cbranch_scc1 L_p29
    s_waitcnt vmcnt(4)
L_p29:
    s_waitcnt vmcnt(30)
    buffer_load_dwordx4 v[148:151], v207, s[28:31], 0 offen nt
    v_dot2c_f32_bf16_dpp v10, v24, v152 row_newbcast:7 row_mask:0xf bank_mask:0xf
    v_dot2c_f32_bf16_dpp v11, v25, v152 row_newbcast:7 row_mask:0xf bank_mask:0xf
    v_dot2c_f32_bf16_dpp v12, v24, v153 row_newbcast:7 row_mask:0xf bank_mask:0xf
    v_dot2c_f32_bf16_dpp v13, v25, v153 row_newbcast:7 row_mask:0xf bank_mask:0xf
    v_dot2c_f32_bf16_dpp v14, v24, v154 row_newbcast:7 row_mask:0xf bank_mask:0xf
    v_dot2c_f32_bf16_dpp v15, v25, v154 row_newbcast:7 row_mask:0xf bank_mask:0xf
    v_dot2c_f32_bf16_dpp v16, v24, v155 row_newbcast:7 row_mask:0xf bank_mask:0xf
    v_dot2c_f32_bf16_dpp v17, v25, v155 row_newbcast:7 row_mask:0xf bank_mask:0xf
    v_xor_b32 v207, 2786816, v206
    s_cbranch_scc1 L_p30
    s_waitcnt vmcnt(4)
L_p30:
    s_waitcnt vmcnt(30)
    buffer_load_dwordx4 v[152:155], v207, s[28:31], 0 offen nt
    v_dot2c_f32_bf16_dpp v10, v24, v156 row_newbcast:15 row_mask:0xf bank_mask:0xf
    v_dot2c_f32_bf16_dpp v11, v25, v156 row_newbcast:15 row_mask:0xf bank_mask:0xf
    v_dot2c_f32_bf16_dpp v12, v24, v157 row_newbcast:15 row_mask:0xf bank_mask:0xf
    v_dot2c_f32_bf16_dpp v13, v25, v157 row_newbcast:15 row_mask:0xf bank_mask:0xf
    v_dot2c_f32_bf16_dpp v14, v24, v158 row_newbcast:15 row_mask:0xf bank_mask:0xf
    v_dot2c_f32_bf16_dpp v15, v25, v158 row_newbcast:15 row_mask:0xf bank_mask:0xf
    v_dot2c_f32_bf16_dpp v16, v24, v159 row_newbcast:15 row_mask:0xf bank_mask:0xf
    v_dot2c_f32_bf16_dpp v17, v25, v159 row_newbcast:15 row_mask:0xf bank_mask:0xf
    v_xor_b32 v207, 2860544, v206
    s_cbranch_scc1 L_p31
    s_waitcnt vmcnt(4)
L_p31:
    s_waitcnt vmcnt(30)
    buffer_load_dwordx4 v[156:159], v207, s[28:31], 0 offen nt
    s_add_u32 s56, s56, 1
    s_barrier
    s_cmp_lt_u32 s56, 7
    s_cbranch_scc1 L_vloop
    s_waitcnt lgkmcnt(0)
    v_sub_f32 v26, v4, v18
    v_sub_f32 v27, v5, v18
    v_mul_f32 v26, s62, v26
    v_mul_f32 v27, s62, v27
    v_exp_f32 v26, v26
    v_exp_f32 v27, v27
    v_cvt_pk_bf16_f32 v23, 0, v26
    v_cvt_pk_bf16_f32 v22, v26, 0
    v_cvt_pk_bf16_f32 v25, 0, v27
    v_cvt_pk_bf16_f32 v24, v27, 0
    v_add_f32 v19, v19, v23
    v_add_f32 v19, v19, v25
    s_nop 1
    v_add_f32_dpp v19, v19, v19 row_ror:8 row_mask:0xf bank_mask:0xf
    s_nop 1
    v_add_f32_dpp v19, v19, v19 row_ror:4 row_mask:0xf bank_mask:0xf
    s_nop 1
    v_add_f32_dpp v19, v19, v19 row_ror:2 row_mask:0xf bank_mask:0xf
    s_nop 1
    v_add_f32_dpp v19, v19, v19 row_ror:1 row_mask:0xf bank_mask:0xf
    v_mov_b32 v30, v19
    s_nop 1
    v_permlane16_swap_b32 v19, v30
    v_add_f32 v19, v19, v30
    v_mov_b32 v30, v19
    s_nop 1
    v_permlane32_swap_b32 v19, v30
    v_add_f32 v19, v19, v30
    v_mul_f32 v18, s62, v18
    s_lshl_b32 s68, s3, 3
    v_mov_b32 v26, s68
    v_mov_b32 v27, 0
    ds_write_b64 v26, v[18:19] offset:2304
    s_waitcnt vmcnt(31)
    v_dot2c_f32_bf16_dpp v10, v22, v32 row_newbcast:0 row_mask:0xf bank_mask:0xf
    v_dot2c_f32_bf16_dpp v11, v23, v32 row_newbcast:0 row_mask:0xf bank_mask:0xf
    v_dot2c_f32_bf16_dpp v12, v22, v33 row_newbcast:0 row_mask:0xf bank_mask:0xf
    v_dot2c_f32_bf16_dpp v13, v23, v33 row_newbcast:0 row_mask:0xf bank_mask:0xf
    v_dot2c_f32_bf16_dpp v14, v22, v34 row_newbcast:0 row_mask:0xf bank_mask:0xf
    v_dot2c_f32_bf16_dpp v15, v23, v34 row_newbcast:0 row_mask:0xf bank_mask:0xf
    v_dot2c_f32_bf16_dpp v16, v22, v35 row_newbcast:0 row_mask:0xf bank_mask:0xf
    v_dot2c_f32_bf16_dpp v17, v23, v35 row_newbcast:0 row_mask:0xf bank_mask:0xf
    s_waitcnt vmcnt(30)
    v_dot2c_f32_bf16_dpp v10, v22, v36 row_newbcast:8 row_mask:0xf bank_mask:0xf
    v_dot2c_f32_bf16_dpp v11, v23, v36 row_newbcast:8 row_mask:0xf bank_mask:0xf
    v_dot2c_f32_bf16_dpp v12, v22, v37 row_newbcast:8 row_mask:0xf bank_mask:0xf
    v_dot2c_f32_bf16_dpp v13, v23, v37 row_newbcast:8 row_mask:0xf bank_mask:0xf
    v_dot2c_f32_bf16_dpp v14, v22, v38 row_newbcast:8 row_mask:0xf bank_mask:0xf
    v_dot2c_f32_bf16_dpp v15, v23, v38 row_newbcast:8 row_mask:0xf bank_mask:0xf
    v_dot2c_f32_bf16_dpp v16, v22, v39 row_newbcast:8 row_mask:0xf bank_mask:0xf
    v_dot2c_f32_bf16_dpp v17, v23, v39 row_newbcast:8 row_mask:0xf bank_mask:0xf
    s_waitcnt vmcnt(29)
    v_dot2c_f32_bf16_dpp v10, v22, v40 row_newbcast:4 row_mask:0xf bank_mask:0xf
    v_dot2c_f32_bf16_dpp v11, v23, v40 row_newbcast:4 row_mask:0xf bank_mask:0xf
    v_dot2c_f32_bf16_dpp v12, v22, v41 row_newbcast:4 row_mask:0xf bank_mask:0xf
    v_dot2c_f32_bf16_dpp v13, v23, v41 row_newbcast:4 row_mask:0xf bank_mask:0xf
    v_dot2c_f32_bf16_dpp v14, v22, v42 row_newbcast:4 row_mask:0xf bank_mask:0xf
    v_dot2c_f32_bf16_dpp v15, v23, v42 row_newbcast:4 row_mask:0xf bank_mask:0xf
    v_dot2c_f32_bf16_dpp v16, v22, v43 row_newbcast:4 row_mask:0xf bank_mask:0xf
    v_dot2c_f32_bf16_dpp v17, v23, v43 row_newbcast:4 row_mask:0xf bank_mask:0xf
    s_waitcnt vmcnt(28)
    v_dot2c_f32_bf16_dpp v10, v22, v44 row_newbcast:12 row_mask:0xf bank_mask:0xf
    v_dot2c_f32_bf16_dpp v11, v23, v44 row_newbcast:12 row_mask:0xf bank_mask:0xf
    v_dot2c_f32_bf16_dpp v12, v22, v45 row_newbcast:12 row_mask:0xf bank_mask:0xf
    v_dot2c_f32_bf16_dpp v13, v23, v45 row_newbcast:12 row_mask:0xf bank_mask:0xf
    v_dot2c_f32_bf16_dpp v14, v22, v46 row_newbcast:12 row_mask:0xf bank_mask:0xf
    v_dot2c_f32_bf16_dpp v15, v23, v46 row_newbcast:12 row_mask:0xf bank_mask:0xf
    v_dot2c_f32_bf16_dpp v16, v22, v47 row_newbcast:12 row_mask:0xf bank_mask:0xf
    v_dot2c_f32_bf16_dpp v17, v23, v47 row_newbcast:12 row_mask:0xf bank_mask:0xf
    s_waitcnt vmcnt(27)
    v_dot2c_f32_bf16_dpp v10, v22, v48 row_newbcast:2 row_mask:0xf bank_mask:0xf
    v_dot2c_f32_bf16_dpp v11, v23, v48 row_newbcast:2 row_mask:0xf bank_mask:0xf
    v_dot2c_f32_bf16_dpp v12, v22, v49 row_newbcast:2 row_mask:0xf bank_mask:0xf
    v_dot2c_f32_bf16_dpp v13, v23, v49 row_newbcast:2 row_mask:0xf bank_mask:0xf
    v_dot2c_f32_bf16_dpp v14, v22, v50 row_newbcast:2 row_mask:0xf bank_mask:0xf
    v_dot2c_f32_bf16_dpp v15, v23, v50 row_newbcast:2 row_mask:0xf bank_mask:0xf
    v_dot2c_f32_bf16_dpp v16, v22, v51 row_newbcast:2 row_mask:0xf bank_mask:0xf
    v_dot2c_f32_bf16_dpp v17, v23, v51 row_newbcast:2 row_mask:0xf bank_mask:0xf
    s_waitcnt vmcnt(26)
    v_dot2c_f32_bf16_dpp v10, v22, v52 row_newbcast:10 row_mask:0xf bank_mask:0xf
    v_dot2c_f32_bf16_dpp v11, v23, v52 row_newbcast:10 row_mask:0xf bank_mask:0xf
    v_dot2c_f32_bf16_dpp v12, v22, v53 row_newbcast:10 row_mask:0xf bank_mask:0xf
    v_dot2c_f32_bf16_dpp v13, v23, v53 row_newbcast:10 row_mask:0xf bank_mask:0xf
    v_dot2c_f32_bf16_dpp v14, v22, v54 row_newbcast:10 row_mask:0xf bank_mask:0xf
    v_dot2c_f32_bf16_dpp v15, v23, v54 row_newbcast:10 row_mask:0xf bank_mask:0xf
    v_dot2c_f32_bf16_dpp v16, v22, v55 row_newbcast:10 row_mask:0xf bank_mask:0xf
    v_dot2c_f32_bf16_dpp v17, v23, v55 row_newbcast:10 row_mask:0xf bank_mask:0xf
    s_waitcnt lgkmcnt(0)
    s_barrier
    s_waitcnt vmcnt(25)
    v_dot2c_f32_bf16_dpp v10, v22, v56 row_newbcast:6 row_mask:0xf bank_mask:0xf
    v_dot2c_f32_bf16_dpp v11, v23, v56 row_newbcast:6 row_mask:0xf bank_mask:0xf
    v_dot2c_f32_bf16_dpp v12, v22, v57 row_newbcast:6 row_mask:0xf bank_mask:0xf
    v_dot2c_f32_bf16_dpp v13, v23, v57 row_newbcast:6 row_mask:0xf bank_mask:0xf
    v_dot2c_f32_bf16_dpp v14, v22, v58 row_newbcast:6 row_mask:0xf bank_mask:0xf
    v_dot2c_f32_bf16_dpp v15, v23, v58 row_newbcast:6 row_mask:0xf bank_mask:0xf
    v_dot2c_f32_bf16_dpp v16, v22, v59 row_newbcast:6 row_mask:0xf bank_mask:0xf
    v_dot2c_f32_bf16_dpp v17, v23, v59 row_newbcast:6 row_mask:0xf bank_mask:0xf
    s_waitcnt vmcnt(24)
    v_dot2c_f32_bf16_dpp v10, v22, v60 row_newbcast:14 row_mask:0xf bank_mask:0xf
    v_dot2c_f32_bf16_dpp v11, v23, v60 row_newbcast:14 row_mask:0xf bank_mask:0xf
    v_dot2c_f32_bf16_dpp v12, v22, v61 row_newbcast:14 row_mask:0xf bank_mask:0xf
    v_dot2c_f32_bf16_dpp v13, v23, v61 row_newbcast:14 row_mask:0xf bank_mask:0xf
    v_dot2c_f32_bf16_dpp v14, v22, v62 row_newbcast:14 row_mask:0xf bank_mask:0xf
    v_dot2c_f32_bf16_dpp v15, v23, v62 row_newbcast:14 row_mask:0xf bank_mask:0xf
    v_dot2c_f32_bf16_dpp v16, v22, v63 row_newbcast:14 row_mask:0xf bank_mask:0xf
    v_dot2c_f32_bf16_dpp v17, v23, v63 row_newbcast:14 row_mask:0xf bank_mask:0xf
    s_waitcnt vmcnt(23)
    v_dot2c_f32_bf16_dpp v10, v22, v64 row_newbcast:1 row_mask:0xf bank_mask:0xf
    v_dot2c_f32_bf16_dpp v11, v23, v64 row_newbcast:1 row_mask:0xf bank_mask:0xf
    v_dot2c_f32_bf16_dpp v12, v22, v65 row_newbcast:1 row_mask:0xf bank_mask:0xf
    v_dot2c_f32_bf16_dpp v13, v23, v65 row_newbcast:1 row_mask:0xf bank_mask:0xf
    v_dot2c_f32_bf16_dpp v14, v22, v66 row_newbcast:1 row_mask:0xf bank_mask:0xf
    v_dot2c_f32_bf16_dpp v15, v23, v66 row_newbcast:1 row_mask:0xf bank_mask:0xf
    v_dot2c_f32_bf16_dpp v16, v22, v67 row_newbcast:1 row_mask:0xf bank_mask:0xf
    v_dot2c_f32_bf16_dpp v17, v23, v67 row_newbcast:1 row_mask:0xf bank_mask:0xf
    s_waitcnt vmcnt(22)
    v_dot2c_f32_bf16_dpp v10, v22, v68 row_newbcast:9 row_mask:0xf bank_mask:0xf
    v_dot2c_f32_bf16_dpp v11, v23, v68 row_newbcast:9 row_mask:0xf bank_mask:0xf
    v_dot2c_f32_bf16_dpp v12, v22, v69 row_newbcast:9 row_mask:0xf bank_mask:0xf
    v_dot2c_f32_bf16_dpp v13, v23, v69 row_newbcast:9 row_mask:0xf bank_mask:0xf
    v_dot2c_f32_bf16_dpp v14, v22, v70 row_newbcast:9 row_mask:0xf bank_mask:0xf
    v_dot2c_f32_bf16_dpp v15, v23, v70 row_newbcast:9 row_mask:0xf bank_mask:0xf
    v_dot2c_f32_bf16_dpp v16, v22, v71 row_newbcast:9 row_mask:0xf bank_mask:0xf
    v_dot2c_f32_bf16_dpp v17, v23, v71 row_newbcast:9 row_mask:0xf bank_mask:0xf
    s_waitcnt vmcnt(21)
    v_dot2c_f32_bf16_dpp v10, v22, v72 row_newbcast:5 row_mask:0xf bank_mask:0xf
    v_dot2c_f32_bf16_dpp v11, v23, v72 row_newbcast:5 row_mask:0xf bank_mask:0xf
    v_dot2c_f32_bf16_dpp v12, v22, v73 row_newbcast:5 row_mask:0xf bank_mask:0xf
    v_dot2c_f32_bf16_dpp v13, v23, v73 row_newbcast:5 row_mask:0xf bank_mask:0xf
    v_dot2c_f32_bf16_dpp v14, v22, v74 row_newbcast:5 row_mask:0xf bank_mask:0xf
    v_dot2c_f32_bf16_dpp v15, v23, v74 row_newbcast:5 row_mask:0xf bank_mask:0xf
    v_dot2c_f32_bf16_dpp v16, v22, v75 row_newbcast:5 row_mask:0xf bank_mask:0xf
    v_dot2c_f32_bf16_dpp v17, v23, v75 row_newbcast:5 row_mask:0xf bank_mask:0xf
    s_waitcnt vmcnt(20)
    v_dot2c_f32_bf16_dpp v10, v22, v76 row_newbcast:13 row_mask:0xf bank_mask:0xf
    v_dot2c_f32_bf16_dpp v11, v23, v76 row_newbcast:13 row_mask:0xf bank_mask:0xf
    v_dot2c_f32_bf16_dpp v12, v22, v77 row_newbcast:13 row_mask:0xf bank_mask:0xf
    v_dot2c_f32_bf16_dpp v13, v23, v77 row_newbcast:13 row_mask:0xf bank_mask:0xf
    v_dot2c_f32_bf16_dpp v14, v22, v78 row_newbcast:13 row_mask:0xf bank_mask:0xf
    v_dot2c_f32_bf16_dpp v15, v23, v78 row_newbcast:13 row_mask:0xf bank_mask:0xf
    v_dot2c_f32_bf16_dpp v16, v22, v79 row_newbcast:13 row_mask:0xf bank_mask:0xf
    v_dot2c_f32_bf16_dpp v17, v23, v79 row_newbcast:13 row_mask:0xf bank_mask:0xf
    buffer_load_dwordx4 v[168:171], v200, s[40:43], s39 offen offset:0 nt
    buffer_load_dwordx4 v[172:175], v200, s[40:43], s39 offen offset:1280 nt
    s_add_u32 s39, s39, 10240
    buffer_load_dwordx4 v[176:179], v200, s[40:43], s39 offen offset:0 nt
    buffer_load_dwordx4 v[180:183], v200, s[40:43], s39 offen offset:1280 nt
    s_add_u32 s39, s39, 10240
    buffer_load_dwordx4 v[184:187], v200, s[40:43], s39 offen offset:0 nt
    buffer_load_dwordx4 v[188:191], v200, s[40:43], s39 offen offset:1280 nt
    s_add_u32 s39, s39, 10240
    buffer_load_dwordx4 v[192:195], v200, s[40:43], s39 offen offset:0 nt
    buffer_load_dwordx4 v[196:199], v200, s[40:43], s39 offen offset:1280 nt
    ds_read_b128 v[64:67], v27 offset:2304
    ds_read_b128 v[68:71], v27 offset:2320
    ds_read_b64 v[204:205], v202 offset:54016
    s_waitcnt vmcnt(27)
    v_dot2c_f32_bf16_dpp v10, v22, v80 row_newbcast:3 row_mask:0xf bank_mask:0xf
    v_dot2c_f32_bf16_dpp v11, v23, v80 row_newbcast:3 row_mask:0xf bank_mask:0xf
    v_dot2c_f32_bf16_dpp v12, v22, v81 row_newbcast:3 row_mask:0xf bank_mask:0xf
    v_dot2c_f32_bf16_dpp v13, v23, v81 row_newbcast:3 row_mask:0xf bank_mask:0xf
    v_dot2c_f32_bf16_dpp v14, v22, v82 row_newbcast:3 row_mask:0xf bank_mask:0xf
    v_dot2c_f32_bf16_dpp v15, v23, v82 row_newbcast:3 row_mask:0xf bank_mask:0xf
    v_dot2c_f32_bf16_dpp v16, v22, v83 row_newbcast:3 row_mask:0xf bank_mask:0xf
    v_dot2c_f32_bf16_dpp v17, v23, v83 row_newbcast:3 row_mask:0xf bank_mask:0xf
    s_waitcnt vmcnt(26)
    v_dot2c_f32_bf16_dpp v10, v22, v84 row_newbcast:11 row_mask:0xf bank_mask:0xf
    v_dot2c_f32_bf16_dpp v11, v23, v84 row_newbcast:11 row_mask:0xf bank_mask:0xf
    v_dot2c_f32_bf16_dpp v12, v22, v85 row_newbcast:11 row_mask:0xf bank_mask:0xf
    v_dot2c_f32_bf16_dpp v13, v23, v85 row_newbcast:11 row_mask:0xf bank_mask:0xf
    v_dot2c_f32_bf16_dpp v14, v22, v86 row_newbcast:11 row_mask:0xf bank_mask:0xf
    v_dot2c_f32_bf16_dpp v15, v23, v86 row_newbcast:11 row_mask:0xf bank_mask:0xf
    v_dot2c_f32_bf16_dpp v16, v22, v87 row_newbcast:11 row_mask:0xf bank_mask:0xf
    v_dot2c_f32_bf16_dpp v17, v23, v87 row_newbcast:11 row_mask:0xf bank_mask:0xf
    s_waitcnt lgkmcnt(0)
    v_max3_f32 v72, v64, v66, v68
    v_max_f32 v72, v72, v70
    v_sub_f32 v64, v64, v72
    v_sub_f32 v66, v66, v72
    v_sub_f32 v68, v68, v72
    v_sub_f32 v70, v70, v72
    v_sub_f32 v76, v18, v72
    v_exp_f32 v64, v64
    v_exp_f32 v66, v66
    v_exp_f32 v68, v68
    v_exp_f32 v70, v70
    v_exp_f32 v76, v76
    v_mov_b32 v73, s55
    v_mov_b32 v75, s55
    v_mov_b32 v79, s55
    v_mul_f32 v74, v64, v65
    v_fmac_f32 v74, v66, v67
    v_fmac_f32 v74, v68, v69
    v_fmac_f32 v74, v70, v71
    s_mov_b64 exec, 1
    buffer_store_dwordx4 v[72:75], v2, s[44:47], s65 offen offset:512 sc1
    s_mov_b64 exec, -1
    v_rcp_f32 v77, v74
    s_nop 0
    v_mul_f32 v76, v76, v77
    s_waitcnt vmcnt(26)
    v_dot2c_f32_bf16_dpp v10, v22, v88 row_newbcast:7 row_mask:0xf bank_mask:0xf
    v_dot2c_f32_bf16_dpp v11, v23, v88 row_newbcast:7 row_mask:0xf bank_mask:0xf
    v_dot2c_f32_bf16_dpp v12, v22, v89 row_newbcast:7 row_mask:0xf bank_mask:0xf
    v_dot2c_f32_bf16_dpp v13, v23, v89 row_newbcast:7 row_mask:0xf bank_mask:0xf
    v_dot2c_f32_bf16_dpp v14, v22, v90 row_newbcast:7 row_mask:0xf bank_mask:0xf
    v_dot2c_f32_bf16_dpp v15, v23, v90 row_newbcast:7 row_mask:0xf bank_mask:0xf
    v_dot2c_f32_bf16_dpp v16, v22, v91 row_newbcast:7 row_mask:0xf bank_mask:0xf
    v_dot2c_f32_bf16_dpp v17, v23, v91 row_newbcast:7 row_mask:0xf bank_mask:0xf
    s_waitcnt vmcnt(25)
    v_dot2c_f32_bf16_dpp v10, v22, v92 row_newbcast:15 row_mask:0xf bank_mask:0xf
    v_dot2c_f32_bf16_dpp v11, v23, v92 row_newbcast:15 row_mask:0xf bank_mask:0xf
    v_dot2c_f32_bf16_dpp v12, v22, v93 row_newbcast:15 row_mask:0xf bank_mask:0xf
    v_dot2c_f32_bf16_dpp v13, v23, v93 row_newbcast:15 row_mask:0xf bank_mask:0xf
    v_dot2c_f32_bf16_dpp v14, v22, v94 row_newbcast:15 row_mask:0xf bank_mask:0xf
    v_dot2c_f32_bf16_dpp v15, v23, v94 row_newbcast:15 row_mask:0xf bank_mask:0xf
    v_dot2c_f32_bf16_dpp v16, v22, v95 row_newbcast:15 row_mask:0xf bank_mask:0xf
    v_dot2c_f32_bf16_dpp v17, v23, v95 row_newbcast:15 row_mask:0xf bank_mask:0xf
    s_waitcnt vmcnt(24)
    v_dot2c_f32_bf16_dpp v10, v24, v96 row_newbcast:0 row_mask:0xf bank_mask:0xf
    v_dot2c_f32_bf16_dpp v11, v25, v96 row_newbcast:0 row_mask:0xf bank_mask:0xf
    v_dot2c_f32_bf16_dpp v12, v24, v97 row_newbcast:0 row_mask:0xf bank_mask:0xf
    v_dot2c_f32_bf16_dpp v13, v25, v97 row_newbcast:0 row_mask:0xf bank_mask:0xf
    v_dot2c_f32_bf16_dpp v14, v24, v98 row_newbcast:0 row_mask:0xf bank_mask:0xf
    v_dot2c_f32_bf16_dpp v15, v25, v98 row_newbcast:0 row_mask:0xf bank_mask:0xf
    v_dot2c_f32_bf16_dpp v16, v24, v99 row_newbcast:0 row_mask:0xf bank_mask:0xf
    v_dot2c_f32_bf16_dpp v17, v25, v99 row_newbcast:0 row_mask:0xf bank_mask:0xf
    s_waitcnt vmcnt(23)
    v_dot2c_f32_bf16_dpp v10, v24, v100 row_newbcast:8 row_mask:0xf bank_mask:0xf
    v_dot2c_f32_bf16_dpp v11, v25, v100 row_newbcast:8 row_mask:0xf bank_mask:0xf
    v_dot2c_f32_bf16_dpp v12, v24, v101 row_newbcast:8 row_mask:0xf bank_mask:0xf
    v_dot2c_f32_bf16_dpp v13, v25, v101 row_newbcast:8 row_mask:0xf bank_mask:0xf
    v_dot2c_f32_bf16_dpp v14, v24, v102 row_newbcast:8 row_mask:0xf bank_mask:0xf
    v_dot2c_f32_bf16_dpp v15, v25, v102 row_newbcast:8 row_mask:0xf bank_mask:0xf
    v_dot2c_f32_bf16_dpp v16, v24, v103 row_newbcast:8 row_mask:0xf bank_mask:0xf
    v_dot2c_f32_bf16_dpp v17, v25, v103 row_newbcast:8 row_mask:0xf bank_mask:0xf
    s_waitcnt vmcnt(22)
    v_dot2c_f32_bf16_dpp v10, v24, v104 row_newbcast:4 row_mask:0xf bank_mask:0xf
    v_dot2c_f32_bf16_dpp v11, v25, v104 row_newbcast:4 row_mask:0xf bank_mask:0xf
    v_dot2c_f32_bf16_dpp v12, v24, v105 row_newbcast:4 row_mask:0xf bank_mask:0xf
    v_dot2c_f32_bf16_dpp v13, v25, v105 row_newbcast:4 row_mask:0xf bank_mask:0xf
    v_dot2c_f32_bf16_dpp v14, v24, v106 row_newbcast:4 row_mask:0xf bank_mask:0xf
    v_dot2c_f32_bf16_dpp v15, v25, v106 row_newbcast:4 row_mask:0xf bank_mask:0xf
    v_dot2c_f32_bf16_dpp v16, v24, v107 row_newbcast:4 row_mask:0xf bank_mask:0xf
    v_dot2c_f32_bf16_dpp v17, v25, v107 row_newbcast:4 row_mask:0xf bank_mask:0xf
    s_waitcnt vmcnt(21)
    v_dot2c_f32_bf16_dpp v10, v24, v108 row_newbcast:12 row_mask:0xf bank_mask:0xf
    v_dot2c_f32_bf16_dpp v11, v25, v108 row_newbcast:12 row_mask:0xf bank_mask:0xf
    v_dot2c_f32_bf16_dpp v12, v24, v109 row_newbcast:12 row_mask:0xf bank_mask:0xf
    v_dot2c_f32_bf16_dpp v13, v25, v109 row_newbcast:12 row_mask:0xf bank_mask:0xf
    v_dot2c_f32_bf16_dpp v14, v24, v110 row_newbcast:12 row_mask:0xf bank_mask:0xf
    v_dot2c_f32_bf16_dpp v15, v25, v110 row_newbcast:12 row_mask:0xf bank_mask:0xf
    v_dot2c_f32_bf16_dpp v16, v24, v111 row_newbcast:12 row_mask:0xf bank_mask:0xf
    v_dot2c_f32_bf16_dpp v17, v25, v111 row_newbcast:12 row_mask:0xf bank_mask:0xf
    s_waitcnt vmcnt(20)
    v_dot2c_f32_bf16_dpp v10, v24, v112 row_newbcast:2 row_mask:0xf bank_mask:0xf
    v_dot2c_f32_bf16_dpp v11, v25, v112 row_newbcast:2 row_mask:0xf bank_mask:0xf
    v_dot2c_f32_bf16_dpp v12, v24, v113 row_newbcast:2 row_mask:0xf bank_mask:0xf
    v_dot2c_f32_bf16_dpp v13, v25, v113 row_newbcast:2 row_mask:0xf bank_mask:0xf
    v_dot2c_f32_bf16_dpp v14, v24, v114 row_newbcast:2 row_mask:0xf bank_mask:0xf
    v_dot2c_f32_bf16_dpp v15, v25, v114 row_newbcast:2 row_mask:0xf bank_mask:0xf
    v_dot2c_f32_bf16_dpp v16, v24, v115 row_newbcast:2 row_mask:0xf bank_mask:0xf
    v_dot2c_f32_bf16_dpp v17, v25, v115 row_newbcast:2 row_mask:0xf bank_mask:0xf
    s_waitcnt vmcnt(19)
    v_dot2c_f32_bf16_dpp v10, v24, v116 row_newbcast:10 row_mask:0xf bank_mask:0xf
    v_dot2c_f32_bf16_dpp v11, v25, v116 row_newbcast:10 row_mask:0xf bank_mask:0xf
    v_dot2c_f32_bf16_dpp v12, v24, v117 row_newbcast:10 row_mask:0xf bank_mask:0xf
    v_dot2c_f32_bf16_dpp v13, v25, v117 row_newbcast:10 row_mask:0xf bank_mask:0xf
    v_dot2c_f32_bf16_dpp v14, v24, v118 row_newbcast:10 row_mask:0xf bank_mask:0xf
    v_dot2c_f32_bf16_dpp v15, v25, v118 row_newbcast:10 row_mask:0xf bank_mask:0xf
    v_dot2c_f32_bf16_dpp v16, v24, v119 row_newbcast:10 row_mask:0xf bank_mask:0xf
    v_dot2c_f32_bf16_dpp v17, v25, v119 row_newbcast:10 row_mask:0xf bank_mask:0xf
    s_waitcnt vmcnt(18)
    v_dot2c_f32_bf16_dpp v10, v24, v120 row_newbcast:6 row_mask:0xf bank_mask:0xf
    v_dot2c_f32_bf16_dpp v11, v25, v120 row_newbcast:6 row_mask:0xf bank_mask:0xf
    v_dot2c_f32_bf16_dpp v12, v24, v121 row_newbcast:6 row_mask:0xf bank_mask:0xf
    v_dot2c_f32_bf16_dpp v13, v25, v121 row_newbcast:6 row_mask:0xf bank_mask:0xf
    v_dot2c_f32_bf16_dpp v14, v24, v122 row_newbcast:6 row_mask:0xf bank_mask:0xf
    v_dot2c_f32_bf16_dpp v15, v25, v122 row_newbcast:6 row_mask:0xf bank_mask:0xf
    v_dot2c_f32_bf16_dpp v16, v24, v123 row_newbcast:6 row_mask:0xf bank_mask:0xf
    v_dot2c_f32_bf16_dpp v17, v25, v123 row_newbcast:6 row_mask:0xf bank_mask:0xf
    s_waitcnt vmcnt(17)
    v_dot2c_f32_bf16_dpp v10, v24, v124 row_newbcast:14 row_mask:0xf bank_mask:0xf
    v_dot2c_f32_bf16_dpp v11, v25, v124 row_newbcast:14 row_mask:0xf bank_mask:0xf
    v_dot2c_f32_bf16_dpp v12, v24, v125 row_newbcast:14 row_mask:0xf bank_mask:0xf
    v_dot2c_f32_bf16_dpp v13, v25, v125 row_newbcast:14 row_mask:0xf bank_mask:0xf
    v_dot2c_f32_bf16_dpp v14, v24, v126 row_newbcast:14 row_mask:0xf bank_mask:0xf
    v_dot2c_f32_bf16_dpp v15, v25, v126 row_newbcast:14 row_mask:0xf bank_mask:0xf
    v_dot2c_f32_bf16_dpp v16, v24, v127 row_newbcast:14 row_mask:0xf bank_mask:0xf
    v_dot2c_f32_bf16_dpp v17, v25, v127 row_newbcast:14 row_mask:0xf bank_mask:0xf
    s_waitcnt vmcnt(16)
    v_dot2c_f32_bf16_dpp v10, v24, v128 row_newbcast:1 row_mask:0xf bank_mask:0xf
    v_dot2c_f32_bf16_dpp v11, v25, v128 row_newbcast:1 row_mask:0xf bank_mask:0xf
    v_dot2c_f32_bf16_dpp v12, v24, v129 row_newbcast:1 row_mask:0xf bank_mask:0xf
    v_dot2c_f32_bf16_dpp v13, v25, v129 row_newbcast:1 row_mask:0xf bank_mask:0xf
    v_dot2c_f32_bf16_dpp v14, v24, v130 row_newbcast:1 row_mask:0xf bank_mask:0xf
    v_dot2c_f32_bf16_dpp v15, v25, v130 row_newbcast:1 row_mask:0xf bank_mask:0xf
    v_dot2c_f32_bf16_dpp v16, v24, v131 row_newbcast:1 row_mask:0xf bank_mask:0xf
    v_dot2c_f32_bf16_dpp v17, v25, v131 row_newbcast:1 row_mask:0xf bank_mask:0xf
    s_waitcnt vmcnt(15)
    v_dot2c_f32_bf16_dpp v10, v24, v132 row_newbcast:9 row_mask:0xf bank_mask:0xf
    v_dot2c_f32_bf16_dpp v11, v25, v132 row_newbcast:9 row_mask:0xf bank_mask:0xf
    v_dot2c_f32_bf16_dpp v12, v24, v133 row_newbcast:9 row_mask:0xf bank_mask:0xf
    v_dot2c_f32_bf16_dpp v13, v25, v133 row_newbcast:9 row_mask:0xf bank_mask:0xf
    v_dot2c_f32_bf16_dpp v14, v24, v134 row_newbcast:9 row_mask:0xf bank_mask:0xf
    v_dot2c_f32_bf16_dpp v15, v25, v134 row_newbcast:9 row_mask:0xf bank_mask:0xf
    v_dot2c_f32_bf16_dpp v16, v24, v135 row_newbcast:9 row_mask:0xf bank_mask:0xf
    v_dot2c_f32_bf16_dpp v17, v25, v135 row_newbcast:9 row_mask:0xf bank_mask:0xf
    s_waitcnt vmcnt(14)
    v_dot2c_f32_bf16_dpp v10, v24, v136 row_newbcast:5 row_mask:0xf bank_mask:0xf
    v_dot2c_f32_bf16_dpp v11, v25, v136 row_newbcast:5 row_mask:0xf bank_mask:0xf
    v_dot2c_f32_bf16_dpp v12, v24, v137 row_newbcast:5 row_mask:0xf bank_mask:0xf
    v_dot2c_f32_bf16_dpp v13, v25, v137 row_newbcast:5 row_mask:0xf bank_mask:0xf
    v_dot2c_f32_bf16_dpp v14, v24, v138 row_newbcast:5 row_mask:0xf bank_mask:0xf
    v_dot2c_f32_bf16_dpp v15, v25, v138 row_newbcast:5 row_mask:0xf bank_mask:0xf
    v_dot2c_f32_bf16_dpp v16, v24, v139 row_newbcast:5 row_mask:0xf bank_mask:0xf
    v_dot2c_f32_bf16_dpp v17, v25, v139 row_newbcast:5 row_mask:0xf bank_mask:0xf
    s_waitcnt vmcnt(13)
    v_dot2c_f32_bf16_dpp v10, v24, v140 row_newbcast:13 row_mask:0xf bank_mask:0xf
    v_dot2c_f32_bf16_dpp v11, v25, v140 row_newbcast:13 row_mask:0xf bank_mask:0xf
    v_dot2c_f32_bf16_dpp v12, v24, v141 row_newbcast:13 row_mask:0xf bank_mask:0xf
    v_dot2c_f32_bf16_dpp v13, v25, v141 row_newbcast:13 row_mask:0xf bank_mask:0xf
    v_dot2c_f32_bf16_dpp v14, v24, v142 row_newbcast:13 row_mask:0xf bank_mask:0xf
    v_dot2c_f32_bf16_dpp v15, v25, v142 row_newbcast:13 row_mask:0xf bank_mask:0xf
    v_dot2c_f32_bf16_dpp v16, v24, v143 row_newbcast:13 row_mask:0xf bank_mask:0xf
    v_dot2c_f32_bf16_dpp v17, v25, v143 row_newbcast:13 row_mask:0xf bank_mask:0xf
    s_waitcnt vmcnt(12)
    v_dot2c_f32_bf16_dpp v10, v24, v144 row_newbcast:3 row_mask:0xf bank_mask:0xf
    v_dot2c_f32_bf16_dpp v11, v25, v144 row_newbcast:3 row_mask:0xf bank_mask:0xf
    v_dot2c_f32_bf16_dpp v12, v24, v145 row_newbcast:3 row_mask:0xf bank_mask:0xf
    v_dot2c_f32_bf16_dpp v13, v25, v145 row_newbcast:3 row_mask:0xf bank_mask:0xf
    v_dot2c_f32_bf16_dpp v14, v24, v146 row_newbcast:3 row_mask:0xf bank_mask:0xf
    v_dot2c_f32_bf16_dpp v15, v25, v146 row_newbcast:3 row_mask:0xf bank_mask:0xf
    v_dot2c_f32_bf16_dpp v16, v24, v147 row_newbcast:3 row_mask:0xf bank_mask:0xf
    v_dot2c_f32_bf16_dpp v17, v25, v147 row_newbcast:3 row_mask:0xf bank_mask:0xf
    s_waitcnt vmcnt(11)
    v_dot2c_f32_bf16_dpp v10, v24, v148 row_newbcast:11 row_mask:0xf bank_mask:0xf
    v_dot2c_f32_bf16_dpp v11, v25, v148 row_newbcast:11 row_mask:0xf bank_mask:0xf
    v_dot2c_f32_bf16_dpp v12, v24, v149 row_newbcast:11 row_mask:0xf bank_mask:0xf
    v_dot2c_f32_bf16_dpp v13, v25, v149 row_newbcast:11 row_mask:0xf bank_mask:0xf
    v_dot2c_f32_bf16_dpp v14, v24, v150 row_newbcast:11 row_mask:0xf bank_mask:0xf
    v_dot2c_f32_bf16_dpp v15, v25, v150 row_newbcast:11 row_mask:0xf bank_mask:0xf
    v_dot2c_f32_bf16_dpp v16, v24, v151 row_newbcast:11 row_mask:0xf bank_mask:0xf
    v_dot2c_f32_bf16_dpp v17, v25, v151 row_newbcast:11 row_mask:0xf bank_mask:0xf
    s_waitcnt vmcnt(10)
    v_dot2c_f32_bf16_dpp v10, v24, v152 row_newbcast:7 row_mask:0xf bank_mask:0xf
    v_dot2c_f32_bf16_dpp v11, v25, v152 row_newbcast:7 row_mask:0xf bank_mask:0xf
    v_dot2c_f32_bf16_dpp v12, v24, v153 row_newbcast:7 row_mask:0xf bank_mask:0xf
    v_dot2c_f32_bf16_dpp v13, v25, v153 row_newbcast:7 row_mask:0xf bank_mask:0xf
    v_dot2c_f32_bf16_dpp v14, v24, v154 row_newbcast:7 row_mask:0xf bank_mask:0xf
    v_dot2c_f32_bf16_dpp v15, v25, v154 row_newbcast:7 row_mask:0xf bank_mask:0xf
    v_dot2c_f32_bf16_dpp v16, v24, v155 row_newbcast:7 row_mask:0xf bank_mask:0xf
    v_dot2c_f32_bf16_dpp v17, v25, v155 row_newbcast:7 row_mask:0xf bank_mask:0xf
    s_waitcnt vmcnt(9)
    v_dot2c_f32_bf16_dpp v10, v24, v156 row_newbcast:15 row_mask:0xf bank_mask:0xf
    v_dot2c_f32_bf16_dpp v11, v25, v156 row_newbcast:15 row_mask:0xf bank_mask:0xf
    v_dot2c_f32_bf16_dpp v12, v24, v157 row_newbcast:15 row_mask:0xf bank_mask:0xf
    v_dot2c_f32_bf16_dpp v13, v25, v157 row_newbcast:15 row_mask:0xf bank_mask:0xf
    v_dot2c_f32_bf16_dpp v14, v24, v158 row_newbcast:15 row_mask:0xf bank_mask:0xf
    v_dot2c_f32_bf16_dpp v15, v25, v158 row_newbcast:15 row_mask:0xf bank_mask:0xf
    v_dot2c_f32_bf16_dpp v16, v24, v159 row_newbcast:15 row_mask:0xf bank_mask:0xf
    v_dot2c_f32_bf16_dpp v17, v25, v159 row_newbcast:15 row_mask:0xf bank_mask:0xf
    v_permlane32_swap_b32 v10, v14
    v_permlane32_swap_b32 v11, v15
    v_permlane32_swap_b32 v12, v16
    v_permlane32_swap_b32 v13, v17
    v_add_f32 v10, v10, v14
    v_add_f32 v11, v11, v15
    v_add_f32 v12, v12, v16
    v_add_f32 v13, v13, v17
    s_nop 0
    v_permlane16_swap_b32 v10, v12
    v_permlane16_swap_b32 v11, v13
    v_add_f32 v10, v10, v12
    v_add_f32 v11, v11, v13
    v_mul_f32 v10, v10, v76
    v_mul_f32 v11, v11, v76
    ds_write_b64 v166, v[10:11] offset:0
    s_cmp_lg_u32 s3, 0
    s_waitcnt lgkmcnt(0)
    s_barrier
    s_cbranch_scc1 L_nopub
    ds_read_b64 v[80:81], v163 offset:0
    ds_read_b64 v[82:83], v163 offset:512
    ds_read_b64 v[84:85], v163 offset:1024
    ds_read_b64 v[86:87], v163 offset:1536
    s_waitcnt lgkmcnt(2)
    v_add_f32 v80, v80, v82
    v_add_f32 v81, v81, v83
    s_waitcnt lgkmcnt(0)
    v_add_f32 v84, v84, v86
    v_add_f32 v85, v85, v87
    v_add_f32 v80, v80, v84
    v_add_f32 v81, v81, v85
    v_cvt_pk_bf16_f32 v78, v80, v81
    buffer_store_dwordx2 v[78:79], v164, s[44:47], s64 offen sc1
    s_waitcnt vmcnt(2)
    s_branch L_hop1
L_nopub:
    s_waitcnt vmcnt(1)
L_hop1:
    s_cmp_ge_u32 s69, 5
    s_cbranch_scc1 L_red
    buffer_load_dwordx4 v[96:99], v162, s[44:47], s66 offen offset:512 sc1
    buffer_load_dwordx4 v[100:103], v162, s[44:47], s66 offen offset:1536 sc1
    buffer_load_dwordx4 v[104:107], v161, s[44:47], s66 offen offset:0 sc1
    buffer_load_dwordx4 v[108:111], v161, s[44:47], s66 offen offset:256 sc1
    buffer_load_dwordx4 v[112:115], v161, s[44:47], s66 offen offset:1024 sc1
    buffer_load_dwordx4 v[116:119], v161, s[44:47], s66 offen offset:1280 sc1
    s_mov_b32 s38, 0x05040100
    s_mov_b32 s39, 0x07060302
    v_perm_b32 v128, v172, v168, s38
    v_perm_b32 v129, v172, v168, s39
    v_perm_b32 v130, v173, v169, s38
    v_perm_b32 v131, v173, v169, s39
    v_perm_b32 v132, v174, v170, s38
    v_perm_b32 v133, v174, v170, s39
    v_perm_b32 v134, v175, v171, s38
    v_perm_b32 v135, v175, v171, s39
    ds_write_b128 v201, v[128:131] offset:2560
    ds_write_b128 v201, v[132:135] offset:3648
    v_perm_b32 v136, v180, v176, s38
    v_perm_b32 v137, v180, v176, s39
    v_perm_b32 v138, v181, v177, s38
    v_perm_b32 v139, v181, v177, s39
    v_perm_b32 v140, v182, v178, s38
    v_perm_b32 v141, v182, v178, s39
    v_perm_b32 v142, v183, v179, s38
    v_perm_b32 v143, v183, v179, s39
    ds_write_b128 v201, v[136:139] offset:2576
    ds_write_b128 v201, v[140:143] offset:3664
    v_perm_b32 v144, v188, v184, s38
    v_perm_b32 v145, v188, v184, s39
    v_perm_b32 v146, v189, v185, s38
    v_perm_b32 v147, v189, v185, s39
    v_perm_b32 v148, v190, v186, s38
    v_perm_b32 v149, v190, v186, s39
    v_perm_b32 v150, v191, v187, s38
    v_perm_b32 v151, v191, v187, s39
    ds_write_b128 v201, v[144:147] offset:2592
    ds_write_b128 v201, v[148:151] offset:3680
    v_perm_b32 v152, v196, v192, s38
    v_perm_b32 v153, v196, v192, s39
    v_perm_b32 v154, v197, v193, s38
    v_perm_b32 v155, v197, v193, s39
    v_perm_b32 v156, v198, v194, s38
    v_perm_b32 v157, v198, v194, s39
    v_perm_b32 v158, v199, v195, s38
    v_perm_b32 v159, v199, v195, s39
    ds_write_b128 v201, v[152:155] offset:2608
    ds_write_b128 v201, v[156:159] offset:3696
    s_waitcnt lgkmcnt(0)
    s_barrier
    ds_read_b128 v[32:35], v160 offset:2560
    ds_read_b128 v[36:39], v160 offset:3648
    ds_read_b128 v[40:43], v160 offset:4736
    ds_read_b128 v[44:47], v160 offset:5824
    ds_read_b128 v[48:51], v160 offset:6912
    ds_read_b128 v[52:55], v160 offset:8000
    ds_read_b128 v[56:59], v160 offset:9088
    ds_read_b128 v[60:63], v160 offset:10176
    s_waitcnt vmcnt(4)
    s_branch L_chkml
L_pollml:
    buffer_load_dwordx4 v[96:99], v162, s[44:47], s66 offen offset:512 sc1
    buffer_load_dwordx4 v[100:103], v162, s[44:47], s66 offen offset:1536 sc1
    s_waitcnt vmcnt(0)
L_chkml:
    v_min3_u32 v22, v97, v99, s55
    v_max3_u32 v23, v97, v99, s55
    v_min3_u32 v22, v101, v103, v22
    v_max3_u32 v23, v101, v103, v23
    v_cmp_ne_u32 vcc, v22, v23
    s_cbranch_vccz L_gotml
    s_mov_b64 exec, vcc
    s_sub_u32 s57, s57, 1
    s_cmp_gt_i32 s57, 0
    s_cbranch_scc1 L_pollml
L_gotml:
    s_mov_b64 exec, -1
    v_max_f32 v22, v96, v100
    v_mov_b32 v23, v22
    s_nop 1
    v_permlane16_swap_b32 v22, v23
    v_max_f32 v22, v22, v23
    v_mov_b32 v23, v22
    s_nop 1
    v_permlane32_swap_b32 v22, v23
    v_max_f32 v22, v22, v23
    v_sub_f32 v96, v96, v22
    v_sub_f32 v100, v100, v22
    v_exp_f32 v96, v96
    v_exp_f32 v100, v100
    v_mov_b32 v11, s55
    v_mul_f32 v96, v96, v98
    v_mul_f32 v100, v100, v102
    v_add_f32 v22, v96, v100
    v_mov_b32 v23, v22
    s_nop 1
    v_permlane16_swap_b32 v22, v23
    v_add_f32 v22, v22, v23
    v_mov_b32 v23, v22
    s_nop 1
    v_permlane32_swap_b32 v22, v23
    v_add_f32 v22, v22, v23
    v_rcp_f32 v22, v22
    v_mov_b32 v13, s55
    v_mul_f32 v96, v96, v22
    v_mul_f32 v100, v100, v22
    s_branch L_chkd
L_polld:
    buffer_load_dwordx4 v[104:107], v161, s[44:47], s66 offen offset:0 sc1
    buffer_load_dwordx4 v[108:111], v161, s[44:47], s66 offen offset:256 sc1
    buffer_load_dwordx4 v[112:115], v161, s[44:47], s66 offen offset:1024 sc1
    buffer_load_dwordx4 v[116:119], v161, s[44:47], s66 offen offset:1280 sc1
L_chkd:
    s_waitcnt vmcnt(0)
    v_min3_u32 v22, v105, v107, s55
    v_max3_u32 v23, v105, v107, s55
    v_min3_u32 v22, v109, v111, v22
    v_max3_u32 v23, v109, v111, v23
    v_min3_u32 v22, v113, v115, v22
    v_max3_u32 v23, v113, v115, v23
    v_min3_u32 v22, v117, v119, v22
    v_max3_u32 v23, v117, v119, v23
    v_cmp_ne_u32 vcc, v22, v23
    s_cbranch_vccz L_gotd
    s_mov_b64 exec, vcc
    s_sub_u32 s57, s57, 1
    s_cmp_gt_i32 s57, 0
    s_cbranch_scc1 L_polld
L_gotd:
    s_mov_b64 exec, -1
    v_lshlrev_b32 v120, 16, v104
    v_and_b32 v121, 0xffff0000, v104
    v_lshlrev_b32 v105, 16, v112
    v_and_b32 v113, 0xffff0000, v112
    v_lshlrev_b32 v122, 16, v106
    v_and_b32 v123, 0xffff0000, v106
    v_lshlrev_b32 v107, 16, v114
    v_and_b32 v115, 0xffff0000, v114
    v_lshlrev_b32 v124, 16, v108
    v_and_b32 v125, 0xffff0000, v108
    v_lshlrev_b32 v109, 16, v116
    v_and_b32 v117, 0xffff0000, v116
    v_lshlrev_b32 v126, 16, v110
    v_and_b32 v127, 0xffff0000, v110
    v_lshlrev_b32 v111, 16, v118
    v_and_b32 v119, 0xffff0000, v118
    v_mul_f32 v120, v96, v120
    v_mul_f32 v121, v96, v121
    v_mul_f32 v122, v96, v122
    v_mul_f32 v123, v96, v123
    v_mul_f32 v124, v96, v124
    v_mul_f32 v125, v96, v125
    v_mul_f32 v126, v96, v126
    v_mul_f32 v127, v96, v127
    v_fmac_f32 v120, v100, v105
    v_fmac_f32 v121, v100, v113
    v_fmac_f32 v122, v100, v107
    v_fmac_f32 v123, v100, v115
    v_fmac_f32 v124, v100, v109
    v_fmac_f32 v125, v100, v117
    v_fmac_f32 v126, v100, v111
    v_fmac_f32 v127, v100, v119
    v_permlane32_swap_b32 v120, v124
    v_permlane32_swap_b32 v121, v125
    v_permlane32_swap_b32 v122, v126
    v_permlane32_swap_b32 v123, v127
    v_add_f32 v120, v120, v124
    v_add_f32 v121, v121, v125
    v_add_f32 v122, v122, v126
    v_add_f32 v123, v123, v127
    s_nop 0
    v_permlane16_swap_b32 v120, v122
    v_permlane16_swap_b32 v121, v123
    v_add_f32 v120, v120, v122
    v_add_f32 v121, v121, v123
    v_cvt_pk_bf16_f32 v24, v120, v121
    v_cvt_pk_bf16_f32 v25, v120, v121
    s_nop 1
    v_permlane16_swap_b32 v24, v25
    v_mov_b32 v26, v24
    v_mov_b32 v27, v25
    s_nop 0
    v_permlane32_swap_b32 v24, v26
    v_permlane32_swap_b32 v25, v27
    s_waitcnt lgkmcnt(0)
    v_dot2_f32_bf16 v10, v32, v24, 0
    v_dot2_f32_bf16 v12, v33, v24, 0
    v_dot2_f32_bf16 v14, v34, v24, 0
    v_dot2_f32_bf16 v15, v35, v24, 0
    v_dot2_f32_bf16 v16, v36, v24, 0
    v_dot2_f32_bf16 v17, v37, v24, 0
    v_dot2_f32_bf16 v18, v38, v24, 0
    v_dot2_f32_bf16 v19, v39, v24, 0
    v_dot2_f32_bf16 v10, v40, v25, v10
    v_dot2_f32_bf16 v12, v41, v25, v12
    v_dot2_f32_bf16 v14, v42, v25, v14
    v_dot2_f32_bf16 v15, v43, v25, v15
    v_dot2_f32_bf16 v16, v44, v25, v16
    v_dot2_f32_bf16 v17, v45, v25, v17
    v_dot2_f32_bf16 v18, v46, v25, v18
    v_dot2_f32_bf16 v19, v47, v25, v19
    v_dot2_f32_bf16 v10, v48, v26, v10
    v_dot2_f32_bf16 v12, v49, v26, v12
    v_dot2_f32_bf16 v14, v50, v26, v14
    v_dot2_f32_bf16 v15, v51, v26, v15
    v_dot2_f32_bf16 v16, v52, v26, v16
    v_dot2_f32_bf16 v17, v53, v26, v17
    v_dot2_f32_bf16 v18, v54, v26, v18
    v_dot2_f32_bf16 v19, v55, v26, v19
    v_dot2_f32_bf16 v10, v56, v27, v10
    v_dot2_f32_bf16 v12, v57, v27, v12
    v_dot2_f32_bf16 v14, v58, v27, v14
    v_dot2_f32_bf16 v15, v59, v27, v15
    v_dot2_f32_bf16 v16, v60, v27, v16
    v_dot2_f32_bf16 v17, v61, v27, v17
    v_dot2_f32_bf16 v18, v62, v27, v18
    v_dot2_f32_bf16 v19, v63, v27, v19
    v_add_f32_dpp v10, v10, v10 row_ror:8 row_mask:0xf bank_mask:0x3
    v_add_f32_dpp v12, v12, v12 row_ror:8 row_mask:0xf bank_mask:0x3
    v_add_f32_dpp v14, v14, v14 row_ror:8 row_mask:0xf bank_mask:0x3
    v_add_f32_dpp v15, v15, v15 row_ror:8 row_mask:0xf bank_mask:0x3
    v_add_f32_dpp v10, v16, v16 row_ror:8 row_mask:0xf bank_mask:0xc
    v_add_f32_dpp v12, v17, v17 row_ror:8 row_mask:0xf bank_mask:0xc
    v_add_f32_dpp v14, v18, v18 row_ror:8 row_mask:0xf bank_mask:0xc
    v_add_f32_dpp v15, v19, v19 row_ror:8 row_mask:0xf bank_mask:0xc
    v_add_f32_dpp v10, v10, v10 row_half_mirror row_mask:0xf bank_mask:0x5
    v_add_f32_dpp v12, v12, v12 row_half_mirror row_mask:0xf bank_mask:0x5
    s_nop 0
    v_add_f32_dpp v10, v14, v14 row_half_mirror row_mask:0xf bank_mask:0xa
    v_add_f32_dpp v12, v15, v15 row_half_mirror row_mask:0xf bank_mask:0xa
    s_nop 0
    v_add_f32_dpp v10, v10, v10 quad_perm:[1,0,3,2] row_mask:0xf bank_mask:0xf
    v_add_f32_dpp v12, v12, v12 quad_perm:[1,0,3,2] row_mask:0xf bank_mask:0xf
    s_nop 0
    v_add_f32_dpp v10, v10, v10 quad_perm:[2,3,0,1] row_mask:0xf bank_mask:0xf
    v_add_f32_dpp v12, v12, v12 quad_perm:[2,3,0,1] row_mask:0xf bank_mask:0xf
    s_mov_b32 exec_lo, 0x11111111
    s_mov_b32 exec_hi, 0x11111111
    buffer_store_dwordx4 v[10:13], v165, s[44:47], s67 offen sc1
    s_branch L_fin
L_red:
    s_cmp_eq_u32 s42, 0
    s_cbranch_scc1 L_red2
    v_mov_b32 v96, 0
    v_mov_b32 v98, 0
    v_mov_b32 v100, 0
    v_mov_b32 v101, 0
    v_mov_b32 v102, 0
    v_mov_b32 v103, 0
    v_mov_b32 v104, 0
    v_mov_b32 v105, 0
    v_mov_b32 v97, s55
    v_mov_b32 v99, s55
    v_dot2c_f32_bf16_dpp v96, v204, v168 row_newbcast:0 row_mask:0xf bank_mask:0xf
    v_dot2c_f32_bf16_dpp v98, v205, v168 row_newbcast:0 row_mask:0xf bank_mask:0xf
    v_dot2c_f32_bf16_dpp v100, v204, v169 row_newbcast:0 row_mask:0xf bank_mask:0xf
    v_dot2c_f32_bf16_dpp v101, v205, v169 row_newbcast:0 row_mask:0xf bank_mask:0xf
    v_dot2c_f32_bf16_dpp v102, v204, v170 row_newbcast:0 row_mask:0xf bank_mask:0xf
    v_dot2c_f32_bf16_dpp v103, v205, v170 row_newbcast:0 row_mask:0xf bank_mask:0xf
    v_dot2c_f32_bf16_dpp v104, v204, v171 row_newbcast:0 row_mask:0xf bank_mask:0xf
    v_dot2c_f32_bf16_dpp v105, v205, v171 row_newbcast:0 row_mask:0xf bank_mask:0xf
    v_dot2c_f32_bf16_dpp v96, v204, v172 row_newbcast:1 row_mask:0xf bank_mask:0xf
    v_dot2c_f32_bf16_dpp v98, v205, v172 row_newbcast:1 row_mask:0xf bank_mask:0xf
    v_dot2c_f32_bf16_dpp v100, v204, v173 row_newbcast:1 row_mask:0xf bank_mask:0xf
    v_dot2c_f32_bf16_dpp v101, v205, v173 row_newbcast:1 row_mask:0xf bank_mask:0xf
    v_dot2c_f32_bf16_dpp v102, v204, v174 row_newbcast:1 row_mask:0xf bank_mask:0xf
    v_dot2c_f32_bf16_dpp v103, v205, v174 row_newbcast:1 row_mask:0xf bank_mask:0xf
    v_dot2c_f32_bf16_dpp v104, v204, v175 row_newbcast:1 row_mask:0xf bank_mask:0xf
    v_dot2c_f32_bf16_dpp v105, v205, v175 row_newbcast:1 row_mask:0xf bank_mask:0xf
    v_dot2c_f32_bf16_dpp v96, v204, v176 row_newbcast:2 row_mask:0xf bank_mask:0xf
    v_dot2c_f32_bf16_dpp v98, v205, v176 row_newbcast:2 row_mask:0xf bank_mask:0xf
    v_dot2c_f32_bf16_dpp v100, v204, v177 row_newbcast:2 row_mask:0xf bank_mask:0xf
    v_dot2c_f32_bf16_dpp v101, v205, v177 row_newbcast:2 row_mask:0xf bank_mask:0xf
    v_dot2c_f32_bf16_dpp v102, v204, v178 row_newbcast:2 row_mask:0xf bank_mask:0xf
    v_dot2c_f32_bf16_dpp v103, v205, v178 row_newbcast:2 row_mask:0xf bank_mask:0xf
    v_dot2c_f32_bf16_dpp v104, v204, v179 row_newbcast:2 row_mask:0xf bank_mask:0xf
    v_dot2c_f32_bf16_dpp v105, v205, v179 row_newbcast:2 row_mask:0xf bank_mask:0xf
    v_dot2c_f32_bf16_dpp v96, v204, v180 row_newbcast:3 row_mask:0xf bank_mask:0xf
    v_dot2c_f32_bf16_dpp v98, v205, v180 row_newbcast:3 row_mask:0xf bank_mask:0xf
    v_dot2c_f32_bf16_dpp v100, v204, v181 row_newbcast:3 row_mask:0xf bank_mask:0xf
    v_dot2c_f32_bf16_dpp v101, v205, v181 row_newbcast:3 row_mask:0xf bank_mask:0xf
    v_dot2c_f32_bf16_dpp v102, v204, v182 row_newbcast:3 row_mask:0xf bank_mask:0xf
    v_dot2c_f32_bf16_dpp v103, v205, v182 row_newbcast:3 row_mask:0xf bank_mask:0xf
    v_dot2c_f32_bf16_dpp v104, v204, v183 row_newbcast:3 row_mask:0xf bank_mask:0xf
    v_dot2c_f32_bf16_dpp v105, v205, v183 row_newbcast:3 row_mask:0xf bank_mask:0xf
    v_dot2c_f32_bf16_dpp v96, v204, v184 row_newbcast:4 row_mask:0xf bank_mask:0xf
    v_dot2c_f32_bf16_dpp v98, v205, v184 row_newbcast:4 row_mask:0xf bank_mask:0xf
    v_dot2c_f32_bf16_dpp v100, v204, v185 row_newbcast:4 row_mask:0xf bank_mask:0xf
    v_dot2c_f32_bf16_dpp v101, v205, v185 row_newbcast:4 row_mask:0xf bank_mask:0xf
    v_dot2c_f32_bf16_dpp v102, v204, v186 row_newbcast:4 row_mask:0xf bank_mask:0xf
    v_dot2c_f32_bf16_dpp v103, v205, v186 row_newbcast:4 row_mask:0xf bank_mask:0xf
    v_dot2c_f32_bf16_dpp v104, v204, v187 row_newbcast:4 row_mask:0xf bank_mask:0xf
    v_dot2c_f32_bf16_dpp v105, v205, v187 row_newbcast:4 row_mask:0xf bank_mask:0xf
    v_dot2c_f32_bf16_dpp v96, v204, v188 row_newbcast:5 row_mask:0xf bank_mask:0xf
    v_dot2c_f32_bf16_dpp v98, v205, v188 row_newbcast:5 row_mask:0xf bank_mask:0xf
    v_dot2c_f32_bf16_dpp v100, v204, v189 row_newbcast:5 row_mask:0xf bank_mask:0xf
    v_dot2c_f32_bf16_dpp v101, v205, v189 row_newbcast:5 row_mask:0xf bank_mask:0xf
    v_dot2c_f32_bf16_dpp v102, v204, v190 row_newbcast:5 row_mask:0xf bank_mask:0xf
    v_dot2c_f32_bf16_dpp v103, v205, v190 row_newbcast:5 row_mask:0xf bank_mask:0xf
    v_dot2c_f32_bf16_dpp v104, v204, v191 row_newbcast:5 row_mask:0xf bank_mask:0xf
    v_dot2c_f32_bf16_dpp v105, v205, v191 row_newbcast:5 row_mask:0xf bank_mask:0xf
    v_dot2c_f32_bf16_dpp v96, v204, v192 row_newbcast:6 row_mask:0xf bank_mask:0xf
    v_dot2c_f32_bf16_dpp v98, v205, v192 row_newbcast:6 row_mask:0xf bank_mask:0xf
    v_dot2c_f32_bf16_dpp v100, v204, v193 row_newbcast:6 row_mask:0xf bank_mask:0xf
    v_dot2c_f32_bf16_dpp v101, v205, v193 row_newbcast:6 row_mask:0xf bank_mask:0xf
    v_dot2c_f32_bf16_dpp v102, v204, v194 row_newbcast:6 row_mask:0xf bank_mask:0xf
    v_dot2c_f32_bf16_dpp v103, v205, v194 row_newbcast:6 row_mask:0xf bank_mask:0xf
    v_dot2c_f32_bf16_dpp v104, v204, v195 row_newbcast:6 row_mask:0xf bank_mask:0xf
    v_dot2c_f32_bf16_dpp v105, v205, v195 row_newbcast:6 row_mask:0xf bank_mask:0xf
    v_dot2c_f32_bf16_dpp v96, v204, v196 row_newbcast:7 row_mask:0xf bank_mask:0xf
    v_dot2c_f32_bf16_dpp v98, v205, v196 row_newbcast:7 row_mask:0xf bank_mask:0xf
    v_dot2c_f32_bf16_dpp v100, v204, v197 row_newbcast:7 row_mask:0xf bank_mask:0xf
    v_dot2c_f32_bf16_dpp v101, v205, v197 row_newbcast:7 row_mask:0xf bank_mask:0xf
    v_dot2c_f32_bf16_dpp v102, v204, v198 row_newbcast:7 row_mask:0xf bank_mask:0xf
    v_dot2c_f32_bf16_dpp v103, v205, v198 row_newbcast:7 row_mask:0xf bank_mask:0xf
    v_dot2c_f32_bf16_dpp v104, v204, v199 row_newbcast:7 row_mask:0xf bank_mask:0xf
    v_dot2c_f32_bf16_dpp v105, v205, v199 row_newbcast:7 row_mask:0xf bank_mask:0xf
    v_permlane32_swap_b32 v96, v102
    v_permlane32_swap_b32 v98, v103
    v_permlane32_swap_b32 v100, v104
    v_permlane32_swap_b32 v101, v105
    v_add_f32 v96, v96, v102
    v_add_f32 v98, v98, v103
    v_add_f32 v100, v100, v104
    v_add_f32 v101, v101, v105
    s_nop 0
    v_permlane16_swap_b32 v96, v100
    v_permlane16_swap_b32 v98, v101
    v_add_f32 v96, v96, v100
    v_add_f32 v98, v98, v101
    buffer_store_dwordx4 v[96:99], v203, s[44:47], s37 offen sc1
L_red2:
    s_cmp_lg_u32 s69, 7
    s_cbranch_scc1 L_fin
    s_cmp_ge_u32 s52, 20
    s_cbranch_scc1 L_fin
    s_lshl_b32 s54, s52, 2
    s_add_u32 s54, s54, s3
    v_lshrrev_b32 v24, 1, v1
    v_mul_u32_u24 v20, 5120, v24
    v_and_b32 v27, 1, v1
    v_lshlrev_b32 v25, 5, v27
    v_lshl_add_u32 v22, v20, 1, v25
    v_add_u32 v20, v20, v25
    v_mov_b32 v21, s55
    v_cmp_gt_u32 vcc, 54, v1
    v_mov_b32 v29, 0x7f000000
    s_lshl_b32 s64, s54, 6
    s_add_u32 s66, s64, 1310720
    s_add_u32 s67, s66, 5120
    s_add_u32 s64, s64, 1048576
    v_cndmask_b32 v22, v29, v22, vcc
    v_cndmask_b32 v23, 0, v21, vcc
    s_mov_b32 s36, s4
    s_mov_b32 s37, s5
    s_mov_b32 s38, 1280
    s_mov_b32 s39, 0x20000
    s_mov_b32 s48, s22
    s_mov_b32 s49, s23
    s_mov_b32 s50, 1280
    s_mov_b32 s51, 0x20000
    v_lshrrev_b32 v6, 4, v1
    v_lshl_add_u32 v27, v27, 2, v6
    v_lshlrev_b32 v27, 1, v27
    s_lshl_b32 s65, s54, 4
    buffer_load_ushort v28, v27, s[36:39], s65 offen
    v_mov_b32 v31, 0
L_polly:
    buffer_load_dwordx4 v[32:35], v22, s[44:47], s66 offen sc1
    buffer_load_dwordx4 v[36:39], v22, s[44:47], s66 offen offset:16 sc1
    buffer_load_dwordx4 v[40:43], v22, s[44:47], s67 offen sc1
    buffer_load_dwordx4 v[44:47], v22, s[44:47], s67 offen offset:16 sc1
    s_waitcnt vmcnt(0)
    v_min3_u32 v24, v33, v35, v23
    v_max3_u32 v25, v33, v35, v23
    v_min3_u32 v24, v37, v39, v24
    v_max3_u32 v25, v37, v39, v25
    v_min3_u32 v24, v41, v43, v24
    v_max3_u32 v25, v41, v43, v25
    v_min3_u32 v24, v45, v47, v24
    v_max3_u32 v25, v45, v47, v25
    v_cmp_ne_u32 vcc, v24, v25
    s_cbranch_vccz L_goty
    s_mov_b64 exec, vcc
    s_sub_u32 s57, s57, 1
    s_cmp_gt_i32 s57, 0
    s_cbranch_scc1 L_polly
L_goty:
    s_mov_b64 exec, -1
    buffer_load_dwordx4 v[48:51], v20, s[44:47], s64 offen sc1
    buffer_load_dwordx4 v[52:55], v20, s[44:47], s64 offen offset:16 sc1
    v_add_f32 v32, v32, v40
    v_add_f32 v34, v34, v42
    v_add_f32 v36, v36, v44
    v_add_f32 v38, v38, v46
    s_nop 0
    v_permlane32_swap_b32 v32, v36
    v_permlane32_swap_b32 v34, v38
    v_add_f32 v32, v32, v36
    v_add_f32 v34, v34, v38
    s_nop 1
    v_permlane16_swap_b32 v32, v34
    v_add_f32 v32, v32, v34
    s_nop 1
    v_add_f32_dpp v32, v32, v32 quad_perm:[2,3,0,1] row_mask:0xf bank_mask:0xf
    s_nop 1
    v_add_f32_dpp v32, v32, v32 row_ror:8 row_mask:0xf bank_mask:0xf
    s_nop 1
    v_add_f32_dpp v32, v32, v32 row_ror:4 row_mask:0xf bank_mask:0xf
    v_cvt_pk_bf16_f32 v32, 0, v32
    v_mul_f32 v33, 0xbfb8aa3b, v32
    v_exp_f32 v33, v33
    s_nop 0
    v_add_f32 v33, 1.0, v33
    v_rcp_f32 v33, v33
    s_nop 0
    v_mul_f32 v30, v32, v33
    v_cvt_pk_bf16_f32 v30, 0, v30
    v_lshlrev_b32 v28, 16, v28
    s_branch L_chk2
L_poll2:
    buffer_load_dwordx4 v[48:51], v20, s[44:47], s64 offen sc1
    buffer_load_dwordx4 v[52:55], v20, s[44:47], s64 offen offset:16 sc1
L_chk2:
    s_waitcnt vmcnt(0)
    v_min3_u32 v24, v49, v51, s55
    v_max3_u32 v25, v49, v51, s55
    v_min3_u32 v24, v53, v55, v24
    v_max3_u32 v25, v53, v55, v25
    v_cmp_ne_u32 vcc, v24, v25
    s_cbranch_vccz L_got2
    s_mov_b64 exec, vcc
    s_sub_u32 s57, s57, 1
    s_cmp_gt_i32 s57, 0
    s_cbranch_scc1 L_poll2
L_got2:
    s_mov_b64 exec, -1
    v_permlane32_swap_b32 v48, v52
    v_permlane32_swap_b32 v50, v54
    v_add_f32 v32, v48, v52
    v_add_f32 v34, v50, v54
    s_nop 1
    v_permlane16_swap_b32 v32, v34
    v_add_f32 v32, v32, v34
    s_nop 1
    v_add_f32_dpp v32, v32, v32 quad_perm:[2,3,0,1] row_mask:0xf bank_mask:0xf
    s_nop 1
    v_add_f32_dpp v32, v32, v32 row_ror:8 row_mask:0xf bank_mask:0xf
    s_nop 1
    v_add_f32_dpp v32, v32, v32 row_ror:4 row_mask:0xf bank_mask:0xf
    v_cvt_pk_bf16_f32 v32, 0, v32
    v_mul_f32 v32, v32, v30
    v_cvt_pk_bf16_f32 v32, 0, v32
    v_add_f32 v32, v28, v32
    v_cvt_pk_bf16_f32 v32, v32, 0
    s_mov_b32 exec_lo, 0x00030003
    s_mov_b32 exec_hi, 0x00030003
    buffer_store_short v32, v27, s[48:51], s65 offen
    s_cmp_lg_u32 s54, 0
    s_cbranch_scc1 L_fin
    s_mov_b64 exec, 1
    buffer_store_dword v21, v31, s[44:47], 0 offen offset:4 sc1
    s_branch L_fin
L_helper:
    s_mov_b32 s3, 4
    s_lshr_b32 s52, s2, 3
    s_add_u32 s69, s2, s52
    s_and_b32 s69, s69, 7
    s_and_b32 s53, s2, 7
    v_lshlrev_b32 v22, 2, v1
    v_lshrrev_b32 v6, 4, v1
    v_and_b32 v7, 15, v1
    v_lshl_add_u32 v8, v7, 2, v6
    v_lshlrev_b32 v8, 1, v8
    v_lshlrev_b32 v9, 4, v7
    v_lshl_add_u32 v9, v6, 13, v9
    s_mul_i32 s68, s53, 80
    s_lshl_b32 s65, s68, 1
    s_lshl_b32 s64, s68, 13
    s_lshl_b32 s66, s52, 8
    s_add_u32 s64, s64, s66
    s_mov_b32 s36, s4
    s_mov_b32 s37, s5
    s_mov_b32 s38, 1280
    s_mov_b32 s39, 0x20000
    s_mov_b32 s40, s10
    s_mov_b32 s41, s11
    s_mov_b32 s42, 5242880
    s_mov_b32 s43, 0x20000
    buffer_load_dword v200, v22, s[36:39], 0 offen offset:0
    buffer_load_dword v201, v22, s[36:39], 0 offen offset:256
    buffer_load_dword v202, v22, s[36:39], 0 offen offset:512
    buffer_load_dword v203, v22, s[36:39], 0 offen offset:768
    buffer_load_dword v204, v22, s[36:39], 0 offen offset:1024
    buffer_load_ushort v205, v8, s[36:39], s65 offen
    buffer_load_ushort v206, v8, s[36:39], s65 offen offset:128
    buffer_load_dwordx4 v[32:35], v9, s[40:43], s64 offen nt
    s_add_u32 s64, s64, 32768
    buffer_load_dwordx4 v[36:39], v9, s[40:43], s64 offen nt
    s_add_u32 s64, s64, 32768
    buffer_load_dwordx4 v[40:43], v9, s[40:43], s64 offen nt
    s_add_u32 s64, s64, 32768
    buffer_load_dwordx4 v[44:47], v9, s[40:43], s64 offen nt
    s_add_u32 s64, s64, 32768
    buffer_load_dwordx4 v[48:51], v9, s[40:43], s64 offen nt
    s_add_u32 s64, s64, 32768
    buffer_load_dwordx4 v[52:55], v9, s[40:43], s64 offen nt
    s_add_u32 s64, s64, 32768
    buffer_load_dwordx4 v[56:59], v9, s[40:43], s64 offen nt
    s_add_u32 s64, s64, 32768
    buffer_load_dwordx4 v[60:63], v9, s[40:43], s64 offen nt
    s_add_u32 s64, s64, 32768
    buffer_load_dwordx4 v[64:67], v9, s[40:43], s64 offen nt
    s_add_u32 s64, s64, 32768
    buffer_load_dwordx4 v[68:71], v9, s[40:43], s64 offen nt
    s_add_u32 s64, s64, 32768
    buffer_load_dwordx4 v[72:75], v9, s[40:43], s64 offen nt
    s_add_u32 s64, s64, 32768
    buffer_load_dwordx4 v[76:79], v9, s[40:43], s64 offen nt
    s_add_u32 s64, s64, 32768
    buffer_load_dwordx4 v[80:83], v9, s[40:43], s64 offen nt
    s_add_u32 s64, s64, 32768
    buffer_load_dwordx4 v[84:87], v9, s[40:43], s64 offen nt
    s_add_u32 s64, s64, 32768
    buffer_load_dwordx4 v[88:91], v9, s[40:43], s64 offen nt
    s_add_u32 s64, s64, 32768
    buffer_load_dwordx4 v[92:95], v9, s[40:43], s64 offen nt
    s_add_u32 s64, s64, 32768
    buffer_load_dwordx4 v[96:99], v9, s[40:43], s64 offen nt
    s_add_u32 s64, s64, 32768
    buffer_load_dwordx4 v[100:103], v9, s[40:43], s64 offen nt
    s_add_u32 s64, s64, 32768
    buffer_load_dwordx4 v[104:107], v9, s[40:43], s64 offen nt
    s_add_u32 s64, s64, 32768
    buffer_load_dwordx4 v[108:111], v9, s[40:43], s64 offen nt
    s_load_dword s55, s[26:27], 4
    v_cmp_gt_u32 vcc, 8, v7
    v_and_b32 v28, 7, v7
    v_lshlrev_b32 v28, 4, v28
    v_mul_u32_u24 v29, 3456, v6
    v_add_u32 v28, v28, v29
    s_mul_i32 s68, s68, 3456
    s_lshl_b32 s66, s52, 7
    s_add_u32 s68, s68, s66
    v_add_u32 v28, s68, v28
    v_mov_b32 v30, s18
    v_mov_b32 v31, s19
    v_mov_b32 v20, s16
    v_mov_b32 v21, s17
    v_cndmask_b32 v30, v30, v20, vcc
    v_cndmask_b32 v31, v31, v21, vcc
    v_add_co_u32 v30, vcc, v30, v28
    s_nop 1
    v_addc_co_u32 v31, vcc, 0, v31, vcc
    s_mov_b32 s34, 13824
    s_mov_b32 s35, 0
    s_cmp_ge_u32 s52, 27
    s_cbranch_scc1 L_nogu
    global_load_dwordx4 v[112:115], v[30:31], off nt
    v_lshl_add_u64 v[30:31], v[30:31], 0, s[34:35]
    global_load_dwordx4 v[116:119], v[30:31], off nt
    v_lshl_add_u64 v[30:31], v[30:31], 0, s[34:35]
    global_load_dwordx4 v[120:123], v[30:31], off nt
    v_lshl_add_u64 v[30:31], v[30:31], 0, s[34:35]
    global_load_dwordx4 v[124:127], v[30:31], off nt
    v_lshl_add_u64 v[30:31], v[30:31], 0, s[34:35]
    global_load_dwordx4 v[128:131], v[30:31], off nt
    v_lshl_add_u64 v[30:31], v[30:31], 0, s[34:35]
    global_load_dwordx4 v[132:135], v[30:31], off nt
    v_lshl_add_u64 v[30:31], v[30:31], 0, s[34:35]
    global_load_dwordx4 v[136:139], v[30:31], off nt
    v_lshl_add_u64 v[30:31], v[30:31], 0, s[34:35]
    global_load_dwordx4 v[140:143], v[30:31], off nt
    v_lshl_add_u64 v[30:31], v[30:31], 0, s[34:35]
    global_load_dwordx4 v[144:147], v[30:31], off nt
    v_lshl_add_u64 v[30:31], v[30:31], 0, s[34:35]
    global_load_dwordx4 v[148:151], v[30:31], off nt
    v_lshl_add_u64 v[30:31], v[30:31], 0, s[34:35]
    global_load_dwordx4 v[152:155], v[30:31], off nt
    v_lshl_add_u64 v[30:31], v[30:31], 0, s[34:35]
    global_load_dwordx4 v[156:159], v[30:31], off nt
    v_lshl_add_u64 v[30:31], v[30:31], 0, s[34:35]
    global_load_dwordx4 v[160:163], v[30:31], off nt
    v_lshl_add_u64 v[30:31], v[30:31], 0, s[34:35]
    global_load_dwordx4 v[164:167], v[30:31], off nt
    v_lshl_add_u64 v[30:31], v[30:31], 0, s[34:35]
    global_load_dwordx4 v[168:171], v[30:31], off nt
    v_lshl_add_u64 v[30:31], v[30:31], 0, s[34:35]
    global_load_dwordx4 v[172:175], v[30:31], off nt
    v_lshl_add_u64 v[30:31], v[30:31], 0, s[34:35]
    global_load_dwordx4 v[176:179], v[30:31], off nt
    v_lshl_add_u64 v[30:31], v[30:31], 0, s[34:35]
    global_load_dwordx4 v[180:183], v[30:31], off nt
    v_lshl_add_u64 v[30:31], v[30:31], 0, s[34:35]
    global_load_dwordx4 v[184:187], v[30:31], off nt
    v_lshl_add_u64 v[30:31], v[30:31], 0, s[34:35]
    global_load_dwordx4 v[188:191], v[30:31], off nt
    s_branch L_gudone
L_nogu:
    v_mov_b32 v29, 0x7f000000
    buffer_load_dword v112, v29, s[36:39], 0 offen
    buffer_load_dword v112, v29, s[36:39], 0 offen
    buffer_load_dword v112, v29, s[36:39], 0 offen
    buffer_load_dword v112, v29, s[36:39], 0 offen
    buffer_load_dword v112, v29, s[36:39], 0 offen
    buffer_load_dword v112, v29, s[36:39], 0 offen
    buffer_load_dword v112, v29, s[36:39], 0 offen
    buffer_load_dword v112, v29, s[36:39], 0 offen
    buffer_load_dword v112, v29, s[36:39], 0 offen
    buffer_load_dword v112, v29, s[36:39], 0 offen
    buffer_load_dword v112, v29, s[36:39], 0 offen
    buffer_load_dword v112, v29, s[36:39], 0 offen
    buffer_load_dword v112, v29, s[36:39], 0 offen
    buffer_load_dword v112, v29, s[36:39], 0 offen
    buffer_load_dword v112, v29, s[36:39], 0 offen
    buffer_load_dword v112, v29, s[36:39], 0 offen
    buffer_load_dword v112, v29, s[36:39], 0 offen
    buffer_load_dword v112, v29, s[36:39], 0 offen
    buffer_load_dword v112, v29, s[36:39], 0 offen
    buffer_load_dword v112, v29, s[36:39], 0 offen
L_gudone:
    s_mov_b32 s57, 4000000
    s_mov_b32 s44, s26
    s_mov_b32 s45, s27
    s_mov_b32 s46, 1703936
    s_mov_b32 s47, 0x20000
    v_lshlrev_b32 v23, 5, v7
    v_lshl_add_u32 v23, v6, 3, v23
    v_lshlrev_b32 v3, 3, v1
    s_movk_i32 s63, 0xff
    v_mov_b32 v24, 0
    v_mov_b32 v25, 0
    v_mov_b32 v10, 0
    v_mov_b32 v11, 0
    v_mov_b32 v12, 0
    v_mov_b32 v13, 0
    v_mov_b32 v14, 0
    v_mov_b32 v15, 0
    s_mul_i32 s66, s2, 512
    s_add_u32 s66, s66, 4096
    s_mul_i32 s67, s52, 4096
    s_add_u32 s67, s67, 4096
    s_waitcnt vmcnt(42)
    v_lshlrev_b32 v210, 16, v200
    v_and_b32 v211, 0xffff0000, v200
    v_lshlrev_b32 v212, 16, v201
    v_and_b32 v213, 0xffff0000, v201
    v_lshlrev_b32 v214, 16, v202
    v_and_b32 v215, 0xffff0000, v202
    v_lshlrev_b32 v216, 16, v203
    v_and_b32 v217, 0xffff0000, v203
    v_lshlrev_b32 v218, 16, v204
    v_and_b32 v219, 0xffff0000, v204
    v_add_f32 v208, v210, v211
    v_add_f32 v209, v212, v213
    v_add_f32 v208, v208, v214
    v_add_f32 v209, v209, v215
    v_add_f32 v208, v208, v216
    v_add_f32 v209, v209, v217
    v_add_f32 v208, v208, v218
    v_add_f32 v209, v209, v219
    v_add_f32 v208, v208, v209
    s_nop 1
    v_add_f32_dpp v208, v208, v208 row_ror:8 row_mask:0xf bank_mask:0xf
    s_nop 1
    v_add_f32_dpp v208, v208, v208 row_ror:4 row_mask:0xf bank_mask:0xf
    s_nop 1
    v_add_f32_dpp v208, v208, v208 row_ror:2 row_mask:0xf bank_mask:0xf
    s_nop 1
    v_add_f32_dpp v208, v208, v208 row_ror:1 row_mask:0xf bank_mask:0xf
    v_mov_b32 v209, v208
    s_nop 1
    v_permlane16_swap_b32 v208, v209
    v_add_f32 v208, v208, v209
    v_mov_b32 v209, v208
    s_nop 1
    v_permlane32_swap_b32 v208, v209
    v_add_f32 v208, v208, v209
    v_mul_f32 v208, 0x3acccccd, v208
    v_sub_f32 v210, v210, v208
    v_sub_f32 v211, v211, v208
    v_sub_f32 v212, v212, v208
    v_sub_f32 v213, v213, v208
    v_sub_f32 v214, v214, v208
    v_sub_f32 v215, v215, v208
    v_sub_f32 v216, v216, v208
    v_sub_f32 v217, v217, v208
    v_sub_f32 v218, v218, v208
    v_sub_f32 v219, v219, v208
    v_mul_f32 v209, v210, v210
    v_mul_f32 v211, v211, v211
    v_fmac_f32 v209, v212, v212
    v_fmac_f32 v211, v213, v213
    v_fmac_f32 v209, v214, v214
    v_fmac_f32 v211, v215, v215
    v_fmac_f32 v209, v216, v216
    v_fmac_f32 v211, v217, v217
    v_fmac_f32 v209, v218, v218
    v_fmac_f32 v211, v219, v219
    v_add_f32 v209, v209, v211
    s_nop 1
    v_add_f32_dpp v209, v209, v209 row_ror:8 row_mask:0xf bank_mask:0xf
    s_nop 1
    v_add_f32_dpp v209, v209, v209 row_ror:4 row_mask:0xf bank_mask:0xf
    s_nop 1
    v_add_f32_dpp v209, v209, v209 row_ror:2 row_mask:0xf bank_mask:0xf
    s_nop 1
    v_add_f32_dpp v209, v209, v209 row_ror:1 row_mask:0xf bank_mask:0xf
    v_mov_b32 v210, v209
    s_nop 1
    v_permlane16_swap_b32 v209, v210
    v_add_f32 v209, v209, v210
    v_mov_b32 v210, v209
    s_nop 1
    v_permlane32_swap_b32 v209, v210
    v_add_f32 v209, v209, v210
    v_mul_f32 v209, 0x3acccccd, v209
    v_cvt_pk_bf16_f32 v208, 0, v208
    v_cvt_pk_bf16_f32 v209, 0, v209
    v_add_f32 v209, 0x3727c5ac, v209
    v_cvt_pk_bf16_f32 v209, 0, v209
    v_sqrt_f32 v209, v209
    s_nop 0
    v_cvt_pk_bf16_f32 v209, 0, v209
    v_rcp_f32 v210, v209
    s_waitcnt vmcnt(40)
    v_lshlrev_b32 v205, 16, v205
    v_sub_f32 v205, v205, v208
    v_cvt_pk_bf16_f32 v205, 0, v205
    v_mul_f32 v22, v205, v210
    v_fma_f32 v205, -v22, v209, v205
    v_fmac_f32 v22, v205, v210
    v_cvt_pk_bf16_f32 v17, 0, v22
    v_cvt_pk_bf16_f32 v16, v22, 0
    v_lshlrev_b32 v206, 16, v206
    v_sub_f32 v206, v206, v208
    v_cvt_pk_bf16_f32 v206, 0, v206
    v_mul_f32 v22, v206, v210
    v_fma_f32 v206, -v22, v209, v206
    v_fmac_f32 v22, v206, v210
    v_cvt_pk_bf16_f32 v19, 0, v22
    v_cvt_pk_bf16_f32 v18, v22, 0
    s_waitcnt vmcnt(39)
    v_dot2c_f32_bf16_dpp v24, v16, v32 row_newbcast:0 row_mask:0xf bank_mask:0xf
    v_dot2c_f32_bf16_dpp v25, v17, v32 row_newbcast:0 row_mask:0xf bank_mask:0xf
    v_dot2c_f32_bf16_dpp v10, v16, v33 row_newbcast:0 row_mask:0xf bank_mask:0xf
    v_dot2c_f32_bf16_dpp v11, v17, v33 row_newbcast:0 row_mask:0xf bank_mask:0xf
    v_dot2c_f32_bf16_dpp v12, v16, v34 row_newbcast:0 row_mask:0xf bank_mask:0xf
    v_dot2c_f32_bf16_dpp v13, v17, v34 row_newbcast:0 row_mask:0xf bank_mask:0xf
    v_dot2c_f32_bf16_dpp v14, v16, v35 row_newbcast:0 row_mask:0xf bank_mask:0xf
    v_dot2c_f32_bf16_dpp v15, v17, v35 row_newbcast:0 row_mask:0xf bank_mask:0xf
    s_waitcnt vmcnt(38)
    v_dot2c_f32_bf16_dpp v24, v16, v36 row_newbcast:1 row_mask:0xf bank_mask:0xf
    v_dot2c_f32_bf16_dpp v25, v17, v36 row_newbcast:1 row_mask:0xf bank_mask:0xf
    v_dot2c_f32_bf16_dpp v10, v16, v37 row_newbcast:1 row_mask:0xf bank_mask:0xf
    v_dot2c_f32_bf16_dpp v11, v17, v37 row_newbcast:1 row_mask:0xf bank_mask:0xf
    v_dot2c_f32_bf16_dpp v12, v16, v38 row_newbcast:1 row_mask:0xf bank_mask:0xf
    v_dot2c_f32_bf16_dpp v13, v17, v38 row_newbcast:1 row_mask:0xf bank_mask:0xf
    v_dot2c_f32_bf16_dpp v14, v16, v39 row_newbcast:1 row_mask:0xf bank_mask:0xf
    v_dot2c_f32_bf16_dpp v15, v17, v39 row_newbcast:1 row_mask:0xf bank_mask:0xf
    s_waitcnt vmcnt(37)
    v_dot2c_f32_bf16_dpp v24, v16, v40 row_newbcast:2 row_mask:0xf bank_mask:0xf
    v_dot2c_f32_bf16_dpp v25, v17, v40 row_newbcast:2 row_mask:0xf bank_mask:0xf
    v_dot2c_f32_bf16_dpp v10, v16, v41 row_newbcast:2 row_mask:0xf bank_mask:0xf
    v_dot2c_f32_bf16_dpp v11, v17, v41 row_newbcast:2 row_mask:0xf bank_mask:0xf
    v_dot2c_f32_bf16_dpp v12, v16, v42 row_newbcast:2 row_mask:0xf bank_mask:0xf
    v_dot2c_f32_bf16_dpp v13, v17, v42 row_newbcast:2 row_mask:0xf bank_mask:0xf
    v_dot2c_f32_bf16_dpp v14, v16, v43 row_newbcast:2 row_mask:0xf bank_mask:0xf
    v_dot2c_f32_bf16_dpp v15, v17, v43 row_newbcast:2 row_mask:0xf bank_mask:0xf
    s_waitcnt vmcnt(36)
    v_dot2c_f32_bf16_dpp v24, v16, v44 row_newbcast:3 row_mask:0xf bank_mask:0xf
    v_dot2c_f32_bf16_dpp v25, v17, v44 row_newbcast:3 row_mask:0xf bank_mask:0xf
    v_dot2c_f32_bf16_dpp v10, v16, v45 row_newbcast:3 row_mask:0xf bank_mask:0xf
    v_dot2c_f32_bf16_dpp v11, v17, v45 row_newbcast:3 row_mask:0xf bank_mask:0xf
    v_dot2c_f32_bf16_dpp v12, v16, v46 row_newbcast:3 row_mask:0xf bank_mask:0xf
    v_dot2c_f32_bf16_dpp v13, v17, v46 row_newbcast:3 row_mask:0xf bank_mask:0xf
    v_dot2c_f32_bf16_dpp v14, v16, v47 row_newbcast:3 row_mask:0xf bank_mask:0xf
    v_dot2c_f32_bf16_dpp v15, v17, v47 row_newbcast:3 row_mask:0xf bank_mask:0xf
    s_waitcnt vmcnt(35)
    v_dot2c_f32_bf16_dpp v24, v16, v48 row_newbcast:4 row_mask:0xf bank_mask:0xf
    v_dot2c_f32_bf16_dpp v25, v17, v48 row_newbcast:4 row_mask:0xf bank_mask:0xf
    v_dot2c_f32_bf16_dpp v10, v16, v49 row_newbcast:4 row_mask:0xf bank_mask:0xf
    v_dot2c_f32_bf16_dpp v11, v17, v49 row_newbcast:4 row_mask:0xf bank_mask:0xf
    v_dot2c_f32_bf16_dpp v12, v16, v50 row_newbcast:4 row_mask:0xf bank_mask:0xf
    v_dot2c_f32_bf16_dpp v13, v17, v50 row_newbcast:4 row_mask:0xf bank_mask:0xf
    v_dot2c_f32_bf16_dpp v14, v16, v51 row_newbcast:4 row_mask:0xf bank_mask:0xf
    v_dot2c_f32_bf16_dpp v15, v17, v51 row_newbcast:4 row_mask:0xf bank_mask:0xf
    s_waitcnt vmcnt(34)
    v_dot2c_f32_bf16_dpp v24, v16, v52 row_newbcast:5 row_mask:0xf bank_mask:0xf
    v_dot2c_f32_bf16_dpp v25, v17, v52 row_newbcast:5 row_mask:0xf bank_mask:0xf
    v_dot2c_f32_bf16_dpp v10, v16, v53 row_newbcast:5 row_mask:0xf bank_mask:0xf
    v_dot2c_f32_bf16_dpp v11, v17, v53 row_newbcast:5 row_mask:0xf bank_mask:0xf
    v_dot2c_f32_bf16_dpp v12, v16, v54 row_newbcast:5 row_mask:0xf bank_mask:0xf
    v_dot2c_f32_bf16_dpp v13, v17, v54 row_newbcast:5 row_mask:0xf bank_mask:0xf
    v_dot2c_f32_bf16_dpp v14, v16, v55 row_newbcast:5 row_mask:0xf bank_mask:0xf
    v_dot2c_f32_bf16_dpp v15, v17, v55 row_newbcast:5 row_mask:0xf bank_mask:0xf
    s_waitcnt vmcnt(33)
    v_dot2c_f32_bf16_dpp v24, v16, v56 row_newbcast:6 row_mask:0xf bank_mask:0xf
    v_dot2c_f32_bf16_dpp v25, v17, v56 row_newbcast:6 row_mask:0xf bank_mask:0xf
    v_dot2c_f32_bf16_dpp v10, v16, v57 row_newbcast:6 row_mask:0xf bank_mask:0xf
    v_dot2c_f32_bf16_dpp v11, v17, v57 row_newbcast:6 row_mask:0xf bank_mask:0xf
    v_dot2c_f32_bf16_dpp v12, v16, v58 row_newbcast:6 row_mask:0xf bank_mask:0xf
    v_dot2c_f32_bf16_dpp v13, v17, v58 row_newbcast:6 row_mask:0xf bank_mask:0xf
    v_dot2c_f32_bf16_dpp v14, v16, v59 row_newbcast:6 row_mask:0xf bank_mask:0xf
    v_dot2c_f32_bf16_dpp v15, v17, v59 row_newbcast:6 row_mask:0xf bank_mask:0xf
    s_waitcnt vmcnt(32)
    v_dot2c_f32_bf16_dpp v24, v16, v60 row_newbcast:7 row_mask:0xf bank_mask:0xf
    v_dot2c_f32_bf16_dpp v25, v17, v60 row_newbcast:7 row_mask:0xf bank_mask:0xf
    v_dot2c_f32_bf16_dpp v10, v16, v61 row_newbcast:7 row_mask:0xf bank_mask:0xf
    v_dot2c_f32_bf16_dpp v11, v17, v61 row_newbcast:7 row_mask:0xf bank_mask:0xf
    v_dot2c_f32_bf16_dpp v12, v16, v62 row_newbcast:7 row_mask:0xf bank_mask:0xf
    v_dot2c_f32_bf16_dpp v13, v17, v62 row_newbcast:7 row_mask:0xf bank_mask:0xf
    v_dot2c_f32_bf16_dpp v14, v16, v63 row_newbcast:7 row_mask:0xf bank_mask:0xf
    v_dot2c_f32_bf16_dpp v15, v17, v63 row_newbcast:7 row_mask:0xf bank_mask:0xf
    s_waitcnt vmcnt(31)
    v_dot2c_f32_bf16_dpp v24, v16, v64 row_newbcast:8 row_mask:0xf bank_mask:0xf
    v_dot2c_f32_bf16_dpp v25, v17, v64 row_newbcast:8 row_mask:0xf bank_mask:0xf
    v_dot2c_f32_bf16_dpp v10, v16, v65 row_newbcast:8 row_mask:0xf bank_mask:0xf
    v_dot2c_f32_bf16_dpp v11, v17, v65 row_newbcast:8 row_mask:0xf bank_mask:0xf
    v_dot2c_f32_bf16_dpp v12, v16, v66 row_newbcast:8 row_mask:0xf bank_mask:0xf
    v_dot2c_f32_bf16_dpp v13, v17, v66 row_newbcast:8 row_mask:0xf bank_mask:0xf
    v_dot2c_f32_bf16_dpp v14, v16, v67 row_newbcast:8 row_mask:0xf bank_mask:0xf
    v_dot2c_f32_bf16_dpp v15, v17, v67 row_newbcast:8 row_mask:0xf bank_mask:0xf
    s_waitcnt vmcnt(30)
    v_dot2c_f32_bf16_dpp v24, v16, v68 row_newbcast:9 row_mask:0xf bank_mask:0xf
    v_dot2c_f32_bf16_dpp v25, v17, v68 row_newbcast:9 row_mask:0xf bank_mask:0xf
    v_dot2c_f32_bf16_dpp v10, v16, v69 row_newbcast:9 row_mask:0xf bank_mask:0xf
    v_dot2c_f32_bf16_dpp v11, v17, v69 row_newbcast:9 row_mask:0xf bank_mask:0xf
    v_dot2c_f32_bf16_dpp v12, v16, v70 row_newbcast:9 row_mask:0xf bank_mask:0xf
    v_dot2c_f32_bf16_dpp v13, v17, v70 row_newbcast:9 row_mask:0xf bank_mask:0xf
    v_dot2c_f32_bf16_dpp v14, v16, v71 row_newbcast:9 row_mask:0xf bank_mask:0xf
    v_dot2c_f32_bf16_dpp v15, v17, v71 row_newbcast:9 row_mask:0xf bank_mask:0xf
    s_waitcnt vmcnt(29)
    v_dot2c_f32_bf16_dpp v24, v16, v72 row_newbcast:10 row_mask:0xf bank_mask:0xf
    v_dot2c_f32_bf16_dpp v25, v17, v72 row_newbcast:10 row_mask:0xf bank_mask:0xf
    v_dot2c_f32_bf16_dpp v10, v16, v73 row_newbcast:10 row_mask:0xf bank_mask:0xf
    v_dot2c_f32_bf16_dpp v11, v17, v73 row_newbcast:10 row_mask:0xf bank_mask:0xf
    v_dot2c_f32_bf16_dpp v12, v16, v74 row_newbcast:10 row_mask:0xf bank_mask:0xf
    v_dot2c_f32_bf16_dpp v13, v17, v74 row_newbcast:10 row_mask:0xf bank_mask:0xf
    v_dot2c_f32_bf16_dpp v14, v16, v75 row_newbcast:10 row_mask:0xf bank_mask:0xf
    v_dot2c_f32_bf16_dpp v15, v17, v75 row_newbcast:10 row_mask:0xf bank_mask:0xf
    s_waitcnt vmcnt(28)
    v_dot2c_f32_bf16_dpp v24, v16, v76 row_newbcast:11 row_mask:0xf bank_mask:0xf
    v_dot2c_f32_bf16_dpp v25, v17, v76 row_newbcast:11 row_mask:0xf bank_mask:0xf
    v_dot2c_f32_bf16_dpp v10, v16, v77 row_newbcast:11 row_mask:0xf bank_mask:0xf
    v_dot2c_f32_bf16_dpp v11, v17, v77 row_newbcast:11 row_mask:0xf bank_mask:0xf
    v_dot2c_f32_bf16_dpp v12, v16, v78 row_newbcast:11 row_mask:0xf bank_mask:0xf
    v_dot2c_f32_bf16_dpp v13, v17, v78 row_newbcast:11 row_mask:0xf bank_mask:0xf
    v_dot2c_f32_bf16_dpp v14, v16, v79 row_newbcast:11 row_mask:0xf bank_mask:0xf
    v_dot2c_f32_bf16_dpp v15, v17, v79 row_newbcast:11 row_mask:0xf bank_mask:0xf
    s_waitcnt vmcnt(27)
    v_dot2c_f32_bf16_dpp v24, v16, v80 row_newbcast:12 row_mask:0xf bank_mask:0xf
    v_dot2c_f32_bf16_dpp v25, v17, v80 row_newbcast:12 row_mask:0xf bank_mask:0xf
    v_dot2c_f32_bf16_dpp v10, v16, v81 row_newbcast:12 row_mask:0xf bank_mask:0xf
    v_dot2c_f32_bf16_dpp v11, v17, v81 row_newbcast:12 row_mask:0xf bank_mask:0xf
    v_dot2c_f32_bf16_dpp v12, v16, v82 row_newbcast:12 row_mask:0xf bank_mask:0xf
    v_dot2c_f32_bf16_dpp v13, v17, v82 row_newbcast:12 row_mask:0xf bank_mask:0xf
    v_dot2c_f32_bf16_dpp v14, v16, v83 row_newbcast:12 row_mask:0xf bank_mask:0xf
    v_dot2c_f32_bf16_dpp v15, v17, v83 row_newbcast:12 row_mask:0xf bank_mask:0xf
    s_waitcnt vmcnt(26)
    v_dot2c_f32_bf16_dpp v24, v16, v84 row_newbcast:13 row_mask:0xf bank_mask:0xf
    v_dot2c_f32_bf16_dpp v25, v17, v84 row_newbcast:13 row_mask:0xf bank_mask:0xf
    v_dot2c_f32_bf16_dpp v10, v16, v85 row_newbcast:13 row_mask:0xf bank_mask:0xf
    v_dot2c_f32_bf16_dpp v11, v17, v85 row_newbcast:13 row_mask:0xf bank_mask:0xf
    v_dot2c_f32_bf16_dpp v12, v16, v86 row_newbcast:13 row_mask:0xf bank_mask:0xf
    v_dot2c_f32_bf16_dpp v13, v17, v86 row_newbcast:13 row_mask:0xf bank_mask:0xf
    v_dot2c_f32_bf16_dpp v14, v16, v87 row_newbcast:13 row_mask:0xf bank_mask:0xf
    v_dot2c_f32_bf16_dpp v15, v17, v87 row_newbcast:13 row_mask:0xf bank_mask:0xf
    s_waitcnt vmcnt(25)
    v_dot2c_f32_bf16_dpp v24, v16, v88 row_newbcast:14 row_mask:0xf bank_mask:0xf
    v_dot2c_f32_bf16_dpp v25, v17, v88 row_newbcast:14 row_mask:0xf bank_mask:0xf
    v_dot2c_f32_bf16_dpp v10, v16, v89 row_newbcast:14 row_mask:0xf bank_mask:0xf
    v_dot2c_f32_bf16_dpp v11, v17, v89 row_newbcast:14 row_mask:0xf bank_mask:0xf
    v_dot2c_f32_bf16_dpp v12, v16, v90 row_newbcast:14 row_mask:0xf bank_mask:0xf
    v_dot2c_f32_bf16_dpp v13, v17, v90 row_newbcast:14 row_mask:0xf bank_mask:0xf
    v_dot2c_f32_bf16_dpp v14, v16, v91 row_newbcast:14 row_mask:0xf bank_mask:0xf
    v_dot2c_f32_bf16_dpp v15, v17, v91 row_newbcast:14 row_mask:0xf bank_mask:0xf
    s_waitcnt vmcnt(24)
    v_dot2c_f32_bf16_dpp v24, v16, v92 row_newbcast:15 row_mask:0xf bank_mask:0xf
    v_dot2c_f32_bf16_dpp v25, v17, v92 row_newbcast:15 row_mask:0xf bank_mask:0xf
    v_dot2c_f32_bf16_dpp v10, v16, v93 row_newbcast:15 row_mask:0xf bank_mask:0xf
    v_dot2c_f32_bf16_dpp v11, v17, v93 row_newbcast:15 row_mask:0xf bank_mask:0xf
    v_dot2c_f32_bf16_dpp v12, v16, v94 row_newbcast:15 row_mask:0xf bank_mask:0xf
    v_dot2c_f32_bf16_dpp v13, v17, v94 row_newbcast:15 row_mask:0xf bank_mask:0xf
    v_dot2c_f32_bf16_dpp v14, v16, v95 row_newbcast:15 row_mask:0xf bank_mask:0xf
    v_dot2c_f32_bf16_dpp v15, v17, v95 row_newbcast:15 row_mask:0xf bank_mask:0xf
    s_waitcnt vmcnt(23)
    v_dot2c_f32_bf16_dpp v24, v18, v96 row_newbcast:0 row_mask:0xf bank_mask:0xf
    v_dot2c_f32_bf16_dpp v25, v19, v96 row_newbcast:0 row_mask:0xf bank_mask:0xf
    v_dot2c_f32_bf16_dpp v10, v18, v97 row_newbcast:0 row_mask:0xf bank_mask:0xf
    v_dot2c_f32_bf16_dpp v11, v19, v97 row_newbcast:0 row_mask:0xf bank_mask:0xf
    v_dot2c_f32_bf16_dpp v12, v18, v98 row_newbcast:0 row_mask:0xf bank_mask:0xf
    v_dot2c_f32_bf16_dpp v13, v19, v98 row_newbcast:0 row_mask:0xf bank_mask:0xf
    v_dot2c_f32_bf16_dpp v14, v18, v99 row_newbcast:0 row_mask:0xf bank_mask:0xf
    v_dot2c_f32_bf16_dpp v15, v19, v99 row_newbcast:0 row_mask:0xf bank_mask:0xf
    s_waitcnt vmcnt(22)
    v_dot2c_f32_bf16_dpp v24, v18, v100 row_newbcast:1 row_mask:0xf bank_mask:0xf
    v_dot2c_f32_bf16_dpp v25, v19, v100 row_newbcast:1 row_mask:0xf bank_mask:0xf
    v_dot2c_f32_bf16_dpp v10, v18, v101 row_newbcast:1 row_mask:0xf bank_mask:0xf
    v_dot2c_f32_bf16_dpp v11, v19, v101 row_newbcast:1 row_mask:0xf bank_mask:0xf
    v_dot2c_f32_bf16_dpp v12, v18, v102 row_newbcast:1 row_mask:0xf bank_mask:0xf
    v_dot2c_f32_bf16_dpp v13, v19, v102 row_newbcast:1 row_mask:0xf bank_mask:0xf
    v_dot2c_f32_bf16_dpp v14, v18, v103 row_newbcast:1 row_mask:0xf bank_mask:0xf
    v_dot2c_f32_bf16_dpp v15, v19, v103 row_newbcast:1 row_mask:0xf bank_mask:0xf
    s_waitcnt vmcnt(21)
    v_dot2c_f32_bf16_dpp v24, v18, v104 row_newbcast:2 row_mask:0xf bank_mask:0xf
    v_dot2c_f32_bf16_dpp v25, v19, v104 row_newbcast:2 row_mask:0xf bank_mask:0xf
    v_dot2c_f32_bf16_dpp v10, v18, v105 row_newbcast:2 row_mask:0xf bank_mask:0xf
    v_dot2c_f32_bf16_dpp v11, v19, v105 row_newbcast:2 row_mask:0xf bank_mask:0xf
    v_dot2c_f32_bf16_dpp v12, v18, v106 row_newbcast:2 row_mask:0xf bank_mask:0xf
    v_dot2c_f32_bf16_dpp v13, v19, v106 row_newbcast:2 row_mask:0xf bank_mask:0xf
    v_dot2c_f32_bf16_dpp v14, v18, v107 row_newbcast:2 row_mask:0xf bank_mask:0xf
    v_dot2c_f32_bf16_dpp v15, v19, v107 row_newbcast:2 row_mask:0xf bank_mask:0xf
    s_waitcnt vmcnt(20)
    v_dot2c_f32_bf16_dpp v24, v18, v108 row_newbcast:3 row_mask:0xf bank_mask:0xf
    v_dot2c_f32_bf16_dpp v25, v19, v108 row_newbcast:3 row_mask:0xf bank_mask:0xf
    v_dot2c_f32_bf16_dpp v10, v18, v109 row_newbcast:3 row_mask:0xf bank_mask:0xf
    v_dot2c_f32_bf16_dpp v11, v19, v109 row_newbcast:3 row_mask:0xf bank_mask:0xf
    v_dot2c_f32_bf16_dpp v12, v18, v110 row_newbcast:3 row_mask:0xf bank_mask:0xf
    v_dot2c_f32_bf16_dpp v13, v19, v110 row_newbcast:3 row_mask:0xf bank_mask:0xf
    v_dot2c_f32_bf16_dpp v14, v18, v111 row_newbcast:3 row_mask:0xf bank_mask:0xf
    v_dot2c_f32_bf16_dpp v15, v19, v111 row_newbcast:3 row_mask:0xf bank_mask:0xf
    s_waitcnt lgkmcnt(0)
    s_add_u32 s55, s55, 1
    v_permlane32_swap_b32 v24, v12
    v_permlane32_swap_b32 v25, v13
    v_permlane32_swap_b32 v10, v14
    v_permlane32_swap_b32 v11, v15
    v_add_f32 v24, v24, v12
    v_add_f32 v25, v25, v13
    v_add_f32 v10, v10, v14
    v_add_f32 v11, v11, v15
    s_nop 0
    v_permlane16_swap_b32 v24, v10
    v_permlane16_swap_b32 v25, v11
    v_add_f32 v24, v24, v10
    v_add_f32 v25, v25, v11
    v_mov_b32 v27, s55
    v_bfi_b32 v24, s63, v27, v24
    v_bfi_b32 v25, s63, v27, v25
    buffer_store_dwordx2 v[24:25], v23, s[44:47], s66 offen sc1
    v_mov_b32 v192, 0
    v_mov_b32 v193, 0
    v_mov_b32 v10, 0
    v_mov_b32 v11, 0
    v_mov_b32 v12, 0
    v_mov_b32 v13, 0
    v_mov_b32 v14, 0
    v_mov_b32 v15, 0
    s_waitcnt vmcnt(1)
    v_dot2c_f32_bf16_dpp v192, v16, v112 row_newbcast:0 row_mask:0xf bank_mask:0xf
    v_dot2c_f32_bf16_dpp v193, v17, v112 row_newbcast:0 row_mask:0xf bank_mask:0xf
    v_dot2c_f32_bf16_dpp v10, v16, v113 row_newbcast:0 row_mask:0xf bank_mask:0xf
    v_dot2c_f32_bf16_dpp v11, v17, v113 row_newbcast:0 row_mask:0xf bank_mask:0xf
    v_dot2c_f32_bf16_dpp v12, v16, v114 row_newbcast:0 row_mask:0xf bank_mask:0xf
    v_dot2c_f32_bf16_dpp v13, v17, v114 row_newbcast:0 row_mask:0xf bank_mask:0xf
    v_dot2c_f32_bf16_dpp v14, v16, v115 row_newbcast:0 row_mask:0xf bank_mask:0xf
    v_dot2c_f32_bf16_dpp v15, v17, v115 row_newbcast:0 row_mask:0xf bank_mask:0xf
    v_dot2c_f32_bf16_dpp v192, v16, v116 row_newbcast:1 row_mask:0xf bank_mask:0xf
    v_dot2c_f32_bf16_dpp v193, v17, v116 row_newbcast:1 row_mask:0xf bank_mask:0xf
    v_dot2c_f32_bf16_dpp v10, v16, v117 row_newbcast:1 row_mask:0xf bank_mask:0xf
    v_dot2c_f32_bf16_dpp v11, v17, v117 row_newbcast:1 row_mask:0xf bank_mask:0xf
    v_dot2c_f32_bf16_dpp v12, v16, v118 row_newbcast:1 row_mask:0xf bank_mask:0xf
    v_dot2c_f32_bf16_dpp v13, v17, v118 row_newbcast:1 row_mask:0xf bank_mask:0xf
    v_dot2c_f32_bf16_dpp v14, v16, v119 row_newbcast:1 row_mask:0xf bank_mask:0xf
    v_dot2c_f32_bf16_dpp v15, v17, v119 row_newbcast:1 row_mask:0xf bank_mask:0xf
    v_dot2c_f32_bf16_dpp v192, v16, v120 row_newbcast:2 row_mask:0xf bank_mask:0xf
    v_dot2c_f32_bf16_dpp v193, v17, v120 row_newbcast:2 row_mask:0xf bank_mask:0xf
    v_dot2c_f32_bf16_dpp v10, v16, v121 row_newbcast:2 row_mask:0xf bank_mask:0xf
    v_dot2c_f32_bf16_dpp v11, v17, v121 row_newbcast:2 row_mask:0xf bank_mask:0xf
    v_dot2c_f32_bf16_dpp v12, v16, v122 row_newbcast:2 row_mask:0xf bank_mask:0xf
    v_dot2c_f32_bf16_dpp v13, v17, v122 row_newbcast:2 row_mask:0xf bank_mask:0xf
    v_dot2c_f32_bf16_dpp v14, v16, v123 row_newbcast:2 row_mask:0xf bank_mask:0xf
    v_dot2c_f32_bf16_dpp v15, v17, v123 row_newbcast:2 row_mask:0xf bank_mask:0xf
    v_dot2c_f32_bf16_dpp v192, v16, v124 row_newbcast:3 row_mask:0xf bank_mask:0xf
    v_dot2c_f32_bf16_dpp v193, v17, v124 row_newbcast:3 row_mask:0xf bank_mask:0xf
    v_dot2c_f32_bf16_dpp v10, v16, v125 row_newbcast:3 row_mask:0xf bank_mask:0xf
    v_dot2c_f32_bf16_dpp v11, v17, v125 row_newbcast:3 row_mask:0xf bank_mask:0xf
    v_dot2c_f32_bf16_dpp v12, v16, v126 row_newbcast:3 row_mask:0xf bank_mask:0xf
    v_dot2c_f32_bf16_dpp v13, v17, v126 row_newbcast:3 row_mask:0xf bank_mask:0xf
    v_dot2c_f32_bf16_dpp v14, v16, v127 row_newbcast:3 row_mask:0xf bank_mask:0xf
    v_dot2c_f32_bf16_dpp v15, v17, v127 row_newbcast:3 row_mask:0xf bank_mask:0xf
    v_dot2c_f32_bf16_dpp v192, v16, v128 row_newbcast:4 row_mask:0xf bank_mask:0xf
    v_dot2c_f32_bf16_dpp v193, v17, v128 row_newbcast:4 row_mask:0xf bank_mask:0xf
    v_dot2c_f32_bf16_dpp v10, v16, v129 row_newbcast:4 row_mask:0xf bank_mask:0xf
    v_dot2c_f32_bf16_dpp v11, v17, v129 row_newbcast:4 row_mask:0xf bank_mask:0xf
    v_dot2c_f32_bf16_dpp v12, v16, v130 row_newbcast:4 row_mask:0xf bank_mask:0xf
    v_dot2c_f32_bf16_dpp v13, v17, v130 row_newbcast:4 row_mask:0xf bank_mask:0xf
    v_dot2c_f32_bf16_dpp v14, v16, v131 row_newbcast:4 row_mask:0xf bank_mask:0xf
    v_dot2c_f32_bf16_dpp v15, v17, v131 row_newbcast:4 row_mask:0xf bank_mask:0xf
    v_dot2c_f32_bf16_dpp v192, v16, v132 row_newbcast:5 row_mask:0xf bank_mask:0xf
    v_dot2c_f32_bf16_dpp v193, v17, v132 row_newbcast:5 row_mask:0xf bank_mask:0xf
    v_dot2c_f32_bf16_dpp v10, v16, v133 row_newbcast:5 row_mask:0xf bank_mask:0xf
    v_dot2c_f32_bf16_dpp v11, v17, v133 row_newbcast:5 row_mask:0xf bank_mask:0xf
    v_dot2c_f32_bf16_dpp v12, v16, v134 row_newbcast:5 row_mask:0xf bank_mask:0xf
    v_dot2c_f32_bf16_dpp v13, v17, v134 row_newbcast:5 row_mask:0xf bank_mask:0xf
    v_dot2c_f32_bf16_dpp v14, v16, v135 row_newbcast:5 row_mask:0xf bank_mask:0xf
    v_dot2c_f32_bf16_dpp v15, v17, v135 row_newbcast:5 row_mask:0xf bank_mask:0xf
    v_dot2c_f32_bf16_dpp v192, v16, v136 row_newbcast:6 row_mask:0xf bank_mask:0xf
    v_dot2c_f32_bf16_dpp v193, v17, v136 row_newbcast:6 row_mask:0xf bank_mask:0xf
    v_dot2c_f32_bf16_dpp v10, v16, v137 row_newbcast:6 row_mask:0xf bank_mask:0xf
    v_dot2c_f32_bf16_dpp v11, v17, v137 row_newbcast:6 row_mask:0xf bank_mask:0xf
    v_dot2c_f32_bf16_dpp v12, v16, v138 row_newbcast:6 row_mask:0xf bank_mask:0xf
    v_dot2c_f32_bf16_dpp v13, v17, v138 row_newbcast:6 row_mask:0xf bank_mask:0xf
    v_dot2c_f32_bf16_dpp v14, v16, v139 row_newbcast:6 row_mask:0xf bank_mask:0xf
    v_dot2c_f32_bf16_dpp v15, v17, v139 row_newbcast:6 row_mask:0xf bank_mask:0xf
    v_dot2c_f32_bf16_dpp v192, v16, v140 row_newbcast:7 row_mask:0xf bank_mask:0xf
    v_dot2c_f32_bf16_dpp v193, v17, v140 row_newbcast:7 row_mask:0xf bank_mask:0xf
    v_dot2c_f32_bf16_dpp v10, v16, v141 row_newbcast:7 row_mask:0xf bank_mask:0xf
    v_dot2c_f32_bf16_dpp v11, v17, v141 row_newbcast:7 row_mask:0xf bank_mask:0xf
    v_dot2c_f32_bf16_dpp v12, v16, v142 row_newbcast:7 row_mask:0xf bank_mask:0xf
    v_dot2c_f32_bf16_dpp v13, v17, v142 row_newbcast:7 row_mask:0xf bank_mask:0xf
    v_dot2c_f32_bf16_dpp v14, v16, v143 row_newbcast:7 row_mask:0xf bank_mask:0xf
    v_dot2c_f32_bf16_dpp v15, v17, v143 row_newbcast:7 row_mask:0xf bank_mask:0xf
    v_dot2c_f32_bf16_dpp v192, v16, v144 row_newbcast:8 row_mask:0xf bank_mask:0xf
    v_dot2c_f32_bf16_dpp v193, v17, v144 row_newbcast:8 row_mask:0xf bank_mask:0xf
    v_dot2c_f32_bf16_dpp v10, v16, v145 row_newbcast:8 row_mask:0xf bank_mask:0xf
    v_dot2c_f32_bf16_dpp v11, v17, v145 row_newbcast:8 row_mask:0xf bank_mask:0xf
    v_dot2c_f32_bf16_dpp v12, v16, v146 row_newbcast:8 row_mask:0xf bank_mask:0xf
    v_dot2c_f32_bf16_dpp v13, v17, v146 row_newbcast:8 row_mask:0xf bank_mask:0xf
    v_dot2c_f32_bf16_dpp v14, v16, v147 row_newbcast:8 row_mask:0xf bank_mask:0xf
    v_dot2c_f32_bf16_dpp v15, v17, v147 row_newbcast:8 row_mask:0xf bank_mask:0xf
    v_dot2c_f32_bf16_dpp v192, v16, v148 row_newbcast:9 row_mask:0xf bank_mask:0xf
    v_dot2c_f32_bf16_dpp v193, v17, v148 row_newbcast:9 row_mask:0xf bank_mask:0xf
    v_dot2c_f32_bf16_dpp v10, v16, v149 row_newbcast:9 row_mask:0xf bank_mask:0xf
    v_dot2c_f32_bf16_dpp v11, v17, v149 row_newbcast:9 row_mask:0xf bank_mask:0xf
    v_dot2c_f32_bf16_dpp v12, v16, v150 row_newbcast:9 row_mask:0xf bank_mask:0xf
    v_dot2c_f32_bf16_dpp v13, v17, v150 row_newbcast:9 row_mask:0xf bank_mask:0xf
    v_dot2c_f32_bf16_dpp v14, v16, v151 row_newbcast:9 row_mask:0xf bank_mask:0xf
    v_dot2c_f32_bf16_dpp v15, v17, v151 row_newbcast:9 row_mask:0xf bank_mask:0xf
    v_dot2c_f32_bf16_dpp v192, v16, v152 row_newbcast:10 row_mask:0xf bank_mask:0xf
    v_dot2c_f32_bf16_dpp v193, v17, v152 row_newbcast:10 row_mask:0xf bank_mask:0xf
    v_dot2c_f32_bf16_dpp v10, v16, v153 row_newbcast:10 row_mask:0xf bank_mask:0xf
    v_dot2c_f32_bf16_dpp v11, v17, v153 row_newbcast:10 row_mask:0xf bank_mask:0xf
    v_dot2c_f32_bf16_dpp v12, v16, v154 row_newbcast:10 row_mask:0xf bank_mask:0xf
    v_dot2c_f32_bf16_dpp v13, v17, v154 row_newbcast:10 row_mask:0xf bank_mask:0xf
    v_dot2c_f32_bf16_dpp v14, v16, v155 row_newbcast:10 row_mask:0xf bank_mask:0xf
    v_dot2c_f32_bf16_dpp v15, v17, v155 row_newbcast:10 row_mask:0xf bank_mask:0xf
    v_dot2c_f32_bf16_dpp v192, v16, v156 row_newbcast:11 row_mask:0xf bank_mask:0xf
    v_dot2c_f32_bf16_dpp v193, v17, v156 row_newbcast:11 row_mask:0xf bank_mask:0xf
    v_dot2c_f32_bf16_dpp v10, v16, v157 row_newbcast:11 row_mask:0xf bank_mask:0xf
    v_dot2c_f32_bf16_dpp v11, v17, v157 row_newbcast:11 row_mask:0xf bank_mask:0xf
    v_dot2c_f32_bf16_dpp v12, v16, v158 row_newbcast:11 row_mask:0xf bank_mask:0xf
    v_dot2c_f32_bf16_dpp v13, v17, v158 row_newbcast:11 row_mask:0xf bank_mask:0xf
    v_dot2c_f32_bf16_dpp v14, v16, v159 row_newbcast:11 row_mask:0xf bank_mask:0xf
    v_dot2c_f32_bf16_dpp v15, v17, v159 row_newbcast:11 row_mask:0xf bank_mask:0xf
    v_dot2c_f32_bf16_dpp v192, v16, v160 row_newbcast:12 row_mask:0xf bank_mask:0xf
    v_dot2c_f32_bf16_dpp v193, v17, v160 row_newbcast:12 row_mask:0xf bank_mask:0xf
    v_dot2c_f32_bf16_dpp v10, v16, v161 row_newbcast:12 row_mask:0xf bank_mask:0xf
    v_dot2c_f32_bf16_dpp v11, v17, v161 row_newbcast:12 row_mask:0xf bank_mask:0xf
    v_dot2c_f32_bf16_dpp v12, v16, v162 row_newbcast:12 row_mask:0xf bank_mask:0xf
    v_dot2c_f32_bf16_dpp v13, v17, v162 row_newbcast:12 row_mask:0xf bank_mask:0xf
    v_dot2c_f32_bf16_dpp v14, v16, v163 row_newbcast:12 row_mask:0xf bank_mask:0xf
    v_dot2c_f32_bf16_dpp v15, v17, v163 row_newbcast:12 row_mask:0xf bank_mask:0xf
    v_dot2c_f32_bf16_dpp v192, v16, v164 row_newbcast:13 row_mask:0xf bank_mask:0xf
    v_dot2c_f32_bf16_dpp v193, v17, v164 row_newbcast:13 row_mask:0xf bank_mask:0xf
    v_dot2c_f32_bf16_dpp v10, v16, v165 row_newbcast:13 row_mask:0xf bank_mask:0xf
    v_dot2c_f32_bf16_dpp v11, v17, v165 row_newbcast:13 row_mask:0xf bank_mask:0xf
    v_dot2c_f32_bf16_dpp v12, v16, v166 row_newbcast:13 row_mask:0xf bank_mask:0xf
    v_dot2c_f32_bf16_dpp v13, v17, v166 row_newbcast:13 row_mask:0xf bank_mask:0xf
    v_dot2c_f32_bf16_dpp v14, v16, v167 row_newbcast:13 row_mask:0xf bank_mask:0xf
    v_dot2c_f32_bf16_dpp v15, v17, v167 row_newbcast:13 row_mask:0xf bank_mask:0xf
    v_dot2c_f32_bf16_dpp v192, v16, v168 row_newbcast:14 row_mask:0xf bank_mask:0xf
    v_dot2c_f32_bf16_dpp v193, v17, v168 row_newbcast:14 row_mask:0xf bank_mask:0xf
    v_dot2c_f32_bf16_dpp v10, v16, v169 row_newbcast:14 row_mask:0xf bank_mask:0xf
    v_dot2c_f32_bf16_dpp v11, v17, v169 row_newbcast:14 row_mask:0xf bank_mask:0xf
    v_dot2c_f32_bf16_dpp v12, v16, v170 row_newbcast:14 row_mask:0xf bank_mask:0xf
    v_dot2c_f32_bf16_dpp v13, v17, v170 row_newbcast:14 row_mask:0xf bank_mask:0xf
    v_dot2c_f32_bf16_dpp v14, v16, v171 row_newbcast:14 row_mask:0xf bank_mask:0xf
    v_dot2c_f32_bf16_dpp v15, v17, v171 row_newbcast:14 row_mask:0xf bank_mask:0xf
    v_dot2c_f32_bf16_dpp v192, v16, v172 row_newbcast:15 row_mask:0xf bank_mask:0xf
    v_dot2c_f32_bf16_dpp v193, v17, v172 row_newbcast:15 row_mask:0xf bank_mask:0xf
    v_dot2c_f32_bf16_dpp v10, v16, v173 row_newbcast:15 row_mask:0xf bank_mask:0xf
    v_dot2c_f32_bf16_dpp v11, v17, v173 row_newbcast:15 row_mask:0xf bank_mask:0xf
    v_dot2c_f32_bf16_dpp v12, v16, v174 row_newbcast:15 row_mask:0xf bank_mask:0xf
    v_dot2c_f32_bf16_dpp v13, v17, v174 row_newbcast:15 row_mask:0xf bank_mask:0xf
    v_dot2c_f32_bf16_dpp v14, v16, v175 row_newbcast:15 row_mask:0xf bank_mask:0xf
    v_dot2c_f32_bf16_dpp v15, v17, v175 row_newbcast:15 row_mask:0xf bank_mask:0xf
    v_dot2c_f32_bf16_dpp v192, v18, v176 row_newbcast:0 row_mask:0xf bank_mask:0xf
    v_dot2c_f32_bf16_dpp v193, v19, v176 row_newbcast:0 row_mask:0xf bank_mask:0xf
    v_dot2c_f32_bf16_dpp v10, v18, v177 row_newbcast:0 row_mask:0xf bank_mask:0xf
    v_dot2c_f32_bf16_dpp v11, v19, v177 row_newbcast:0 row_mask:0xf bank_mask:0xf
    v_dot2c_f32_bf16_dpp v12, v18, v178 row_newbcast:0 row_mask:0xf bank_mask:0xf
    v_dot2c_f32_bf16_dpp v13, v19, v178 row_newbcast:0 row_mask:0xf bank_mask:0xf
    v_dot2c_f32_bf16_dpp v14, v18, v179 row_newbcast:0 row_mask:0xf bank_mask:0xf
    v_dot2c_f32_bf16_dpp v15, v19, v179 row_newbcast:0 row_mask:0xf bank_mask:0xf
    v_dot2c_f32_bf16_dpp v192, v18, v180 row_newbcast:1 row_mask:0xf bank_mask:0xf
    v_dot2c_f32_bf16_dpp v193, v19, v180 row_newbcast:1 row_mask:0xf bank_mask:0xf
    v_dot2c_f32_bf16_dpp v10, v18, v181 row_newbcast:1 row_mask:0xf bank_mask:0xf
    v_dot2c_f32_bf16_dpp v11, v19, v181 row_newbcast:1 row_mask:0xf bank_mask:0xf
    v_dot2c_f32_bf16_dpp v12, v18, v182 row_newbcast:1 row_mask:0xf bank_mask:0xf
    v_dot2c_f32_bf16_dpp v13, v19, v182 row_newbcast:1 row_mask:0xf bank_mask:0xf
    v_dot2c_f32_bf16_dpp v14, v18, v183 row_newbcast:1 row_mask:0xf bank_mask:0xf
    v_dot2c_f32_bf16_dpp v15, v19, v183 row_newbcast:1 row_mask:0xf bank_mask:0xf
    v_dot2c_f32_bf16_dpp v192, v18, v184 row_newbcast:2 row_mask:0xf bank_mask:0xf
    v_dot2c_f32_bf16_dpp v193, v19, v184 row_newbcast:2 row_mask:0xf bank_mask:0xf
    v_dot2c_f32_bf16_dpp v10, v18, v185 row_newbcast:2 row_mask:0xf bank_mask:0xf
    v_dot2c_f32_bf16_dpp v11, v19, v185 row_newbcast:2 row_mask:0xf bank_mask:0xf
    v_dot2c_f32_bf16_dpp v12, v18, v186 row_newbcast:2 row_mask:0xf bank_mask:0xf
    v_dot2c_f32_bf16_dpp v13, v19, v186 row_newbcast:2 row_mask:0xf bank_mask:0xf
    v_dot2c_f32_bf16_dpp v14, v18, v187 row_newbcast:2 row_mask:0xf bank_mask:0xf
    v_dot2c_f32_bf16_dpp v15, v19, v187 row_newbcast:2 row_mask:0xf bank_mask:0xf
    v_dot2c_f32_bf16_dpp v192, v18, v188 row_newbcast:3 row_mask:0xf bank_mask:0xf
    v_dot2c_f32_bf16_dpp v193, v19, v188 row_newbcast:3 row_mask:0xf bank_mask:0xf
    v_dot2c_f32_bf16_dpp v10, v18, v189 row_newbcast:3 row_mask:0xf bank_mask:0xf
    v_dot2c_f32_bf16_dpp v11, v19, v189 row_newbcast:3 row_mask:0xf bank_mask:0xf
    v_dot2c_f32_bf16_dpp v12, v18, v190 row_newbcast:3 row_mask:0xf bank_mask:0xf
    v_dot2c_f32_bf16_dpp v13, v19, v190 row_newbcast:3 row_mask:0xf bank_mask:0xf
    v_dot2c_f32_bf16_dpp v14, v18, v191 row_newbcast:3 row_mask:0xf bank_mask:0xf
    v_dot2c_f32_bf16_dpp v15, v19, v191 row_newbcast:3 row_mask:0xf bank_mask:0xf
    buffer_load_dwordx2 v[32:33], v3, s[44:47], s67 offen offset:0 sc1
    buffer_load_dwordx2 v[34:35], v3, s[44:47], s67 offen offset:512 sc1
    buffer_load_dwordx2 v[36:37], v3, s[44:47], s67 offen offset:1024 sc1
    buffer_load_dwordx2 v[38:39], v3, s[44:47], s67 offen offset:1536 sc1
    buffer_load_dwordx2 v[40:41], v3, s[44:47], s67 offen offset:2048 sc1
    buffer_load_dwordx2 v[42:43], v3, s[44:47], s67 offen offset:2560 sc1
    buffer_load_dwordx2 v[44:45], v3, s[44:47], s67 offen offset:3072 sc1
    buffer_load_dwordx2 v[46:47], v3, s[44:47], s67 offen offset:3584 sc1
    v_permlane32_swap_b32 v192, v12
    v_permlane32_swap_b32 v193, v13
    v_permlane32_swap_b32 v10, v14
    v_permlane32_swap_b32 v11, v15
    v_add_f32 v192, v192, v12
    v_add_f32 v193, v193, v13
    v_add_f32 v10, v10, v14
    v_add_f32 v11, v11, v15
    s_nop 0
    v_permlane16_swap_b32 v192, v10
    v_permlane16_swap_b32 v193, v11
    v_add_f32 v192, v192, v10
    v_add_f32 v193, v193, v11
    s_add_u32 s66, s66, 262144
    s_cmp_ge_u32 s52, 27
    s_cselect_b32 s66, 0x7f000000, s66
    v_bfi_b32 v192, s63, v27, v192
    v_bfi_b32 v193, s63, v27, v193
    buffer_store_dwordx2 v[192:193], v23, s[44:47], s66 offen sc1
    s_waitcnt vmcnt(1)
    s_branch L_chkq
L_pollq:
    buffer_load_dwordx2 v[32:33], v3, s[44:47], s67 offen offset:0 sc1
    buffer_load_dwordx2 v[34:35], v3, s[44:47], s67 offen offset:512 sc1
    buffer_load_dwordx2 v[36:37], v3, s[44:47], s67 offen offset:1024 sc1
    buffer_load_dwordx2 v[38:39], v3, s[44:47], s67 offen offset:1536 sc1
    buffer_load_dwordx2 v[40:41], v3, s[44:47], s67 offen offset:2048 sc1
    buffer_load_dwordx2 v[42:43], v3, s[44:47], s67 offen offset:2560 sc1
    buffer_load_dwordx2 v[44:45], v3, s[44:47], s67 offen offset:3072 sc1
    buffer_load_dwordx2 v[46:47], v3, s[44:47], s67 offen offset:3584 sc1
    s_waitcnt vmcnt(0)
L_chkq:
    v_xor_b32 v28, s55, v32
    v_xor_b32 v29, s55, v33
    v_or_b32 v28, v28, v29
    v_xor_b32 v29, s55, v34
    v_or_b32 v28, v28, v29
    v_xor_b32 v29, s55, v35
    v_or_b32 v28, v28, v29
    v_xor_b32 v29, s55, v36
    v_or_b32 v28, v28, v29
    v_xor_b32 v29, s55, v37
    v_or_b32 v28, v28, v29
    v_xor_b32 v29, s55, v38
    v_or_b32 v28, v28, v29
    v_xor_b32 v29, s55, v39
    v_or_b32 v28, v28, v29
    v_xor_b32 v29, s55, v40
    v_or_b32 v28, v28, v29
    v_xor_b32 v29, s55, v41
    v_or_b32 v28, v28, v29
    v_xor_b32 v29, s55, v42
    v_or_b32 v28, v28, v29
    v_xor_b32 v29, s55, v43
    v_or_b32 v28, v28, v29
    v_xor_b32 v29, s55, v44
    v_or_b32 v28, v28, v29
    v_xor_b32 v29, s55, v45
    v_or_b32 v28, v28, v29
    v_xor_b32 v29, s55, v46
    v_or_b32 v28, v28, v29
    v_xor_b32 v29, s55, v47
    v_or_b32 v28, v28, v29
    v_and_b32 v28, 0xff, v28
    v_cmp_ne_u32 vcc, 0, v28
    s_cbranch_vccz L_gotq
    s_sub_u32 s57, s57, 1
    s_cmp_gt_i32 s57, 0
    s_cbranch_scc1 L_pollq
L_gotq:
    v_mov_b32 v29, 0x80
    v_bfi_b32 v32, s63, v29, v32
    v_bfi_b32 v33, s63, v29, v33
    v_bfi_b32 v34, s63, v29, v34
    v_bfi_b32 v35, s63, v29, v35
    v_bfi_b32 v36, s63, v29, v36
    v_bfi_b32 v37, s63, v29, v37
    v_bfi_b32 v38, s63, v29, v38
    v_bfi_b32 v39, s63, v29, v39
    v_bfi_b32 v40, s63, v29, v40
    v_bfi_b32 v41, s63, v29, v41
    v_bfi_b32 v42, s63, v29, v42
    v_bfi_b32 v43, s63, v29, v43
    v_bfi_b32 v44, s63, v29, v44
    v_bfi_b32 v45, s63, v29, v45
    v_bfi_b32 v46, s63, v29, v46
    v_bfi_b32 v47, s63, v29, v47
    v_add_f32 v32, v32, v40
    v_add_f32 v33, v33, v41
    v_add_f32 v34, v34, v42
    v_add_f32 v35, v35, v43
    v_add_f32 v36, v36, v44
    v_add_f32 v37, v37, v45
    v_add_f32 v38, v38, v46
    v_add_f32 v39, v39, v47
    v_add_f32 v32, v32, v36
    v_add_f32 v33, v33, v37
    v_add_f32 v34, v34, v38
    v_add_f32 v35, v35, v39
    v_add_f32 v32, v32, v34
    v_add_f32 v33, v33, v35
    v_cvt_pk_bf16_f32 v10, v32, v33
    v_lshlrev_b32 v22, 2, v1
    ds_write_b32 v22, v10 offset:2048
    v_mov_b32 v29, 0
    v_mov_b32 v28, 1
    s_waitcnt lgkmcnt(0)
    ds_write_b32 v29, v28 offset:2368
    s_cmp_lt_u32 s69, 5
    s_cbranch_scc1 L_fin
    s_cmp_ge_u32 s52, 27
    s_cbranch_scc1 L_fin
    v_lshlrev_b32 v20, 2, v8
    s_add_u32 s67, s67, 262144
    v_lshlrev_b32 v19, 1, v8
L_pollg:
    buffer_load_dword v32, v19, s[44:47], s67 offen offset:0 sc1
    buffer_load_dword v33, v19, s[44:47], s67 offen offset:256 sc1
    buffer_load_dword v34, v19, s[44:47], s67 offen offset:512 sc1
    buffer_load_dword v35, v19, s[44:47], s67 offen offset:768 sc1
    buffer_load_dword v36, v19, s[44:47], s67 offen offset:1024 sc1
    buffer_load_dword v37, v19, s[44:47], s67 offen offset:1280 sc1
    buffer_load_dword v38, v19, s[44:47], s67 offen offset:1536 sc1
    buffer_load_dword v39, v19, s[44:47], s67 offen offset:1792 sc1
    buffer_load_dword v40, v19, s[44:47], s67 offen offset:2048 sc1
    buffer_load_dword v41, v19, s[44:47], s67 offen offset:2304 sc1
    buffer_load_dword v42, v19, s[44:47], s67 offen offset:2560 sc1
    buffer_load_dword v43, v19, s[44:47], s67 offen offset:2816 sc1
    buffer_load_dword v44, v19, s[44:47], s67 offen offset:3072 sc1
    buffer_load_dword v45, v19, s[44:47], s67 offen offset:3328 sc1
    buffer_load_dword v46, v19, s[44:47], s67 offen offset:3584 sc1
    buffer_load_dword v47, v19, s[44:47], s67 offen offset:3840 sc1
    s_waitcnt vmcnt(0)
    v_xor_b32 v28, s55, v32
    v_xor_b32 v29, s55, v33
    v_or_b32 v28, v28, v29
    v_xor_b32 v29, s55, v34
    v_or_b32 v28, v28, v29
    v_xor_b32 v29, s55, v35
    v_or_b32 v28, v28, v29
    v_xor_b32 v29, s55, v36
    v_or_b32 v28, v28, v29
    v_xor_b32 v29, s55, v37
    v_or_b32 v28, v28, v29
    v_xor_b32 v29, s55, v38
    v_or_b32 v28, v28, v29
    v_xor_b32 v29, s55, v39
    v_or_b32 v28, v28, v29
    v_xor_b32 v29, s55, v40
    v_or_b32 v28, v28, v29
    v_xor_b32 v29, s55, v41
    v_or_b32 v28, v28, v29
    v_xor_b32 v29, s55, v42
    v_or_b32 v28, v28, v29
    v_xor_b32 v29, s55, v43
    v_or_b32 v28, v28, v29
    v_xor_b32 v29, s55, v44
    v_or_b32 v28, v28, v29
    v_xor_b32 v29, s55, v45
    v_or_b32 v28, v28, v29
    v_xor_b32 v29, s55, v46
    v_or_b32 v28, v28, v29
    v_xor_b32 v29, s55, v47
    v_or_b32 v28, v28, v29
    v_and_b32 v28, 0xff, v28
    v_cmp_ne_u32 vcc, 0, v28
    s_cbranch_vccz L_gotg
    s_sub_u32 s57, s57, 1
    s_cmp_gt_i32 s57, 0
    s_cbranch_scc1 L_pollg
L_gotg:
    v_mov_b32 v29, 0x80
    v_bfi_b32 v32, s63, v29, v32
    v_bfi_b32 v33, s63, v29, v33
    v_bfi_b32 v34, s63, v29, v34
    v_bfi_b32 v35, s63, v29, v35
    v_bfi_b32 v36, s63, v29, v36
    v_bfi_b32 v37, s63, v29, v37
    v_bfi_b32 v38, s63, v29, v38
    v_bfi_b32 v39, s63, v29, v39
    v_bfi_b32 v40, s63, v29, v40
    v_bfi_b32 v41, s63, v29, v41
    v_bfi_b32 v42, s63, v29, v42
    v_bfi_b32 v43, s63, v29, v43
    v_bfi_b32 v44, s63, v29, v44
    v_bfi_b32 v45, s63, v29, v45
    v_bfi_b32 v46, s63, v29, v46
    v_bfi_b32 v47, s63, v29, v47
    v_add_f32 v32, v32, v40
    v_add_f32 v33, v33, v41
    v_add_f32 v34, v34, v42
    v_add_f32 v35, v35, v43
    v_add_f32 v36, v36, v44
    v_add_f32 v37, v37, v45
    v_add_f32 v38, v38, v46
    v_add_f32 v39, v39, v47
    v_add_f32 v32, v32, v36
    v_add_f32 v33, v33, v37
    v_add_f32 v34, v34, v38
    v_add_f32 v35, v35, v39
    v_add_f32 v32, v32, v34
    v_add_f32 v33, v33, v35
    v_cvt_pk_bf16_f32 v10, 0, v32
    v_cvt_pk_bf16_f32 v15, 0, v33
    v_mul_f32 v11, v10, v10
    v_mul_f32 v11, v11, v10
    v_mov_b32 v12, 0x3d372713
    v_fma_f32 v11, v11, v12, v10
    v_mul_f32 v11, 0xc0135761, v11
    v_exp_f32 v11, v11
    s_nop 0
    v_add_f32 v11, 1.0, v11
    v_rcp_f32 v11, v11
    s_nop 0
    v_mul_f32 v10, v10, v11
    v_cvt_pk_bf16_f32 v10, 0, v10
    v_mul_f32 v10, v10, v15
    v_cvt_pk_bf16_f32 v25, 0, v10
    v_cvt_pk_bf16_f32 v24, v10, 0
    ds_write_b64 v20, v[24:25] offset:54016
    s_waitcnt lgkmcnt(0)
L_fin:
L_end:
    s_endpgm
.section .rodata,"a"
.p2align 6
.amdhsa_kernel recurrent_scan__gqa_block_cached__geglu_ffn__decode_kernel
  .amdhsa_next_free_vgpr 224
  .amdhsa_next_free_sgpr 72
  .amdhsa_accum_offset 224
  .amdhsa_group_segment_fixed_size 0
  .amdhsa_kernarg_size 96
  .amdhsa_user_sgpr_count 2
  .amdhsa_user_sgpr_kernarg_segment_ptr 1
  .amdhsa_system_sgpr_workgroup_id_x 1
  .amdhsa_float_denorm_mode_32 3
.end_amdhsa_kernel
```
